```python
import torch

def _softmax(x, axis=-1):
    return torch.softmax(x, dim=axis)

def _gelu(x):
    return torch.nn.functional.gelu(x, approximate='tanh')

def _silu(x):
    return torch.nn.functional.silu(x)

def _sigmoid(x):
    return torch.sigmoid(x)

def _layernorm(x, axis=-1, eps=1e-05):
    m = x.mean(dim=axis, keepdim=True)
    v = x.var(dim=axis, keepdim=True, unbiased=False)
    return (x - m) / torch.sqrt(v + eps)

def _scatter_add(tgt, idx, src, axis=0):
    return tgt.clone().index_add_(axis, idx, src)

def _segment_sum(src, seg, n):
    out = torch.zeros((n,) + src.shape[1:], dtype=src.dtype)
    return out.index_add_(0, seg, src)

def _pad(x, pw):
    flat = tuple((v for pair in reversed(pw) for v in pair))
    return torch.nn.functional.pad(x, flat)
kernel_name = 'gather_scatter__tensor_product_equiv_tfn__graph'

def setup_inputs():

    _w = lambda a: (lambda t: t.to(torch.bfloat16) if t.is_floating_point() else t)(torch.as_tensor(a))
    N, deg, C, L, DE = (10000, 64, 64, 1, 16)
    E = N * deg
    M = (L + 1) ** 2
    src = (lambda lo, hi, *s: torch.randint(lo, hi, s))(0, N, E).to(torch.int64)
    dst = (lambda lo, hi, *s: torch.randint(lo, hi, s))(0, N, E).to(torch.int64)
    r = (lambda *s: torch.randn(*s, dtype=torch.bfloat16) * 0.05)(E, 3)
    r = r / (torch.linalg.norm(r, dim=-1, keepdim=True) + 1e-09)
    rx, ry, rz = (r[:, 0].clone(), r[:, 1].clone(), r[:, 2].clone())
    Ys = [torch.ones((E, 1), dtype=float)]
    if L >= 1:
        Ys.append(r.to(float))
    if L >= 2:
        Ys.append(torch.stack([2 * rx * ry, 2 * ry * rz, (3 * rz * rz - 1.0) / (lambda _x: torch.sqrt(torch.as_tensor(_x)))(3.0), 2 * rx * rz, rx * rx - ry * ry], dim=-1).to(float))
    for _l in range(3, L + 1):
        Ys.append(((lambda *s: torch.randn(*s, dtype=torch.bfloat16) * 0.05)(E, 2 * _l + 1) * 0.3).to(float))
    Y = torch.cat(Ys, dim=-1)
    cg = torch.zeros((M, M, M), dtype=float)
    off = [_l * _l for _l in range(L + 2)]
    for l1 in range(L + 1):
        for l2 in range(L + 1):
            for l3 in range(abs(l1 - l2), min(L, l1 + l2) + 1):
                d1, d2, d3 = (2 * l1 + 1, 2 * l2 + 1, 2 * l3 + 1)
                cg[off[l1]:off[l1 + 1], off[l2]:off[l2 + 1], off[l3]:off[l3 + 1]] = (lambda *s: torch.randn(*s, dtype=torch.bfloat16) * 0.05)(d1, d2, d3) / (lambda _x: torch.sqrt(torch.as_tensor(_x)))(float(d1 * d2))
    return {'x': _w((lambda *s: torch.randn(*s, dtype=torch.bfloat16) * 0.05)(N, C, M) * 0.2), 'src': _w(src), 'dst': _w(dst), 'Y': _w(Y), 'edge_feat': _w((lambda *s: torch.randn(*s, dtype=torch.bfloat16) * 0.05)(E, DE)), 'w_rad': _w((lambda *s: torch.randn(*s, dtype=torch.bfloat16) * 0.05)(DE, C) * (1.0 / max(1.0, DE) ** 0.5)), 'cg': _w(cg), 'w_mix': _w((lambda *s: torch.randn(*s, dtype=torch.bfloat16) * 0.05)(C, C) * (1.0 / max(1.0, C) ** 0.5))}

def reference(x, src, dst, Y, edge_feat, w_rad, cg, w_mix):
    N, C, M = (x.shape[0], x.shape[1], x.shape[2])
    R = _silu(edge_feat @ w_rad)
    xs = x[src]
    tp = torch.einsum('eci,ef,ifo->eco', xs, Y, cg)
    msg = R[:, :, None] * tp
    agg = _segment_sum(msg.reshape(-1, C * M), dst, N).reshape(N, C, M)
    return torch.einsum('ncm,cd->ndm', agg, w_mix)
```

```asm
; @launch kernel=tfn_sort_kernel grid=(257,1,1) block=(640,1,1) lds=32768
; @launch kernel=gather_scatter__tensor_product_equiv_tfn__graph_kernel grid=(256,1,1) block=(512,1,1) lds=109312
.amdgcn_target "amdgcn-amd-amdhsa--gfx950"
.text
.globl tfn_sort_kernel
.p2align 8
.type tfn_sort_kernel,@function
tfn_sort_kernel:
    s_cmp_gt_u32 s2, 256
    s_cbranch_scc1 K1_END
    s_load_dwordx2 s[12:13], s[0:1], 16
    s_load_dwordx2 s[16:17], s[0:1], 8
    s_load_dwordx2 s[20:21], s[0:1], 24
    s_load_dwordx2 s[24:25], s[0:1], 80
    s_mov_b32 s26, 0x7f3900
    s_mov_b32 s27, 0x20000
    s_cmp_eq_u32 s2, 256
    s_cbranch_scc1 K1_CONST
    s_sub_u32 s2, 255, s2
    v_lshlrev_b32 v1, 3, v0
    v_lshlrev_b32 v2, 4, v0
    v_and_b32 v3, 0x3f0, v2
    v_mov_b64 v[40:41], 0
    v_mov_b64 v[42:43], 0
    v_mov_b32 v48, 12
    ds_write_b128 v3, v[40:43] offset:30720
    s_mul_i32 s28, s2, 10000
    s_mul_i32 s29, s2, 20000
    s_add_u32 s30, s28, 5000
    s_add_u32 s31, s29, 10000
    v_cmp_gt_u32 vcc, 625, v0
    s_mov_b32 s14, 0x271000
    s_mov_b32 s15, 0x20000
    s_mov_b32 s18, 0x271000
    s_mov_b32 s19, 0x20000
    s_mov_b32 s22, 0x4e2000
    s_mov_b32 s23, 0x20000
    s_mov_b64 s[32:33], vcc
    s_mov_b64 exec, vcc
    s_waitcnt lgkmcnt(0)
    buffer_load_dwordx2 v[4:5], v1, s[12:15], s28 offen nt
    buffer_load_dwordx2 v[6:7], v1, s[12:15], s30 offen nt
    s_barrier
    buffer_load_dwordx2 v[8:9], v1, s[16:19], s28 offen nt
    buffer_load_dwordx2 v[10:11], v1, s[16:19], s30 offen nt
    buffer_load_dwordx4 v[12:15], v2, s[20:23], s29 offen nt
    buffer_load_dwordx4 v[16:19], v2, s[20:23], s31 offen nt
    v_lshlrev_b32 v44, 21, v0
    v_add_u32 v45, 0x100000, v44
    v_add_u32 v46, 0x4e200000, v44
    v_add_u32 v47, 0x4e300000, v44
    s_mov_b32 s39, 2561102
    s_mul_i32 s36, s2, 30720
    s_add_u32 s37, s36, 10240
    s_add_u32 s38, s36, 20480
    s_lshl_b32 s40, s2, 10
    s_add_u32 s40, s40, 0x780000
    v_readfirstlane_b32 s41, v0
    s_cmp_eq_u32 s41, 0
    s_cbranch_scc1 K2_Wa
    s_cmp_eq_u32 s41, 64
    s_cbranch_scc1 K2_Wg
    s_cmp_eq_u32 s41, 128
    s_cbranch_scc1 K2_Wh
K1_BACK:
    s_waitcnt vmcnt(4)
    v_mul_u32_u24 v4, 1677, v4
    v_mul_u32_u24 v5, 1677, v5
    v_mul_u32_u24 v6, 1677, v6
    v_mul_u32_u24 v7, 1677, v7
    v_lshlrev_b32_sdwa v20, 2, v4 dst_sel:DWORD dst_unused:UNUSED_PAD src0_sel:DWORD src1_sel:WORD_1
    v_lshlrev_b32_sdwa v21, 2, v5 dst_sel:DWORD dst_unused:UNUSED_PAD src0_sel:DWORD src1_sel:WORD_1
    v_lshlrev_b32_sdwa v22, 2, v6 dst_sel:DWORD dst_unused:UNUSED_PAD src0_sel:DWORD src1_sel:WORD_1
    v_lshlrev_b32_sdwa v23, 2, v7 dst_sel:DWORD dst_unused:UNUSED_PAD src0_sel:DWORD src1_sel:WORD_1
    ds_add_rtn_u32 v24, v20, v48 offset:30720
    ds_add_rtn_u32 v25, v21, v48 offset:30720
    ds_add_rtn_u32 v26, v22, v48 offset:30720
    ds_add_rtn_u32 v27, v23, v48 offset:30720
    v_mul_hi_u32_u24_sdwa v4, s39, v4 dst_sel:DWORD dst_unused:UNUSED_PAD src0_sel:DWORD src1_sel:WORD_0
    v_mul_hi_u32_u24_sdwa v5, s39, v5 dst_sel:DWORD dst_unused:UNUSED_PAD src0_sel:DWORD src1_sel:WORD_0
    v_mul_hi_u32_u24_sdwa v6, s39, v6 dst_sel:DWORD dst_unused:UNUSED_PAD src0_sel:DWORD src1_sel:WORD_0
    v_mul_hi_u32_u24_sdwa v7, s39, v7 dst_sel:DWORD dst_unused:UNUSED_PAD src0_sel:DWORD src1_sel:WORD_0
    v_lshl_or_b32 v44, v4, 14, v44
    v_lshl_or_b32 v45, v5, 14, v45
    v_lshl_or_b32 v46, v6, 14, v46
    v_lshl_or_b32 v47, v7, 14, v47
    s_mov_b64 exec, -1
    s_waitcnt lgkmcnt(0)
    s_barrier
    ds_read_b128 v[32:35], v3 offset:30720
    s_waitcnt lgkmcnt(0)
    v_add_u32 v37, v32, v33
    v_add_u32 v38, v37, v34
    v_add_u32 v39, v38, v35
    s_nop 1
    v_add_u32_dpp v49, v39, v39 row_shr:1 row_mask:0xf bank_mask:0xf bound_ctrl:0
    s_nop 1
    v_add_u32_dpp v49, v49, v49 row_shr:2 row_mask:0xf bank_mask:0xf bound_ctrl:0
    s_nop 1
    v_add_u32_dpp v49, v49, v49 row_shr:4 row_mask:0xf bank_mask:0xf bound_ctrl:0
    s_nop 1
    v_add_u32_dpp v49, v49, v49 row_shr:8 row_mask:0xf bank_mask:0xf bound_ctrl:0
    s_nop 1
    v_add_u32_dpp v49, v49, v49 row_bcast:15 row_mask:0xa bank_mask:0xf
    s_nop 1
    v_add_u32_dpp v49, v49, v49 row_bcast:31 row_mask:0xc bank_mask:0xf
    v_sub_u32 v40, v49, v39
    v_add_u32 v41, v40, v32
    v_add_u32 v42, v40, v37
    v_add_u32 v43, v40, v38
    ds_write_b128 v3, v[40:43] offset:31744
    s_mov_b64 exec, s[32:33]
    ds_read_b32 v28, v20 offset:31744
    ds_read_b32 v29, v21 offset:31744
    ds_read_b32 v30, v22 offset:31744
    ds_read_b32 v31, v23 offset:31744
    s_waitcnt vmcnt(2)
    v_or_b32 v44, v8, v44
    v_or_b32 v45, v9, v45
    v_or_b32 v46, v10, v46
    v_or_b32 v47, v11, v47
    s_waitcnt lgkmcnt(0)
    v_add_u32 v28, v28, v24
    v_add_u32 v29, v29, v25
    v_add_u32 v30, v30, v26
    v_add_u32 v31, v31, v27
    ds_write_b32 v28, v44 offset:8
    ds_write_b32 v29, v45 offset:8
    ds_write_b32 v30, v46 offset:8
    ds_write_b32 v31, v47 offset:8
    s_mov_b64 exec, -1
    v_cmp_gt_u32 vcc, 64, v0
    s_cbranch_vccz K1_NOTAB
    v_lshl_or_b32 v32, v32, 16, v40
    v_lshl_or_b32 v33, v33, 16, v41
    v_lshl_or_b32 v34, v34, 16, v42
    v_lshl_or_b32 v35, v35, 16, v43
    s_waitcnt vmcnt(0)
    buffer_store_dwordx4 v[32:35], v3, s[24:27], s40 offen sc1
    s_branch K1_TAB
K1_NOTAB:
    s_waitcnt vmcnt(0)
K1_TAB:
    s_mov_b64 exec, s[32:33]
    ds_write2_b32 v28, v12, v13 offset0:0 offset1:1
    ds_write2_b32 v29, v14, v15 offset0:0 offset1:1
    ds_write2_b32 v30, v16, v17 offset0:0 offset1:1
    ds_write2_b32 v31, v18, v19 offset0:0 offset1:1
    s_mov_b64 exec, -1
    s_waitcnt lgkmcnt(0)
    s_barrier
    ds_read_b128 v[4:7], v2 offset:0
    ds_read_b128 v[8:11], v2 offset:10240
    ds_read_b128 v[12:15], v2 offset:20480
    s_waitcnt lgkmcnt(2)
    buffer_store_dwordx4 v[4:7], v2, s[24:27], s36 offen sc1
    s_waitcnt lgkmcnt(1)
    buffer_store_dwordx4 v[8:11], v2, s[24:27], s37 offen sc1
    s_waitcnt lgkmcnt(0)
    buffer_store_dwordx4 v[12:15], v2, s[24:27], s38 offen sc1
K1_END:
    s_endpgm
K1_CONST:
    s_load_dwordx4 s[40:43], s[0:1], 40
    s_load_dwordx2 s[44:45], s[0:1], 56
    v_lshrrev_b32 v1, 6, v0
    v_and_b32 v2, 63, v0
    v_readfirstlane_b32 s28, v1
    v_and_b32 v3, 31, v0
    v_bfe_u32 v4, v0, 5, 1
    v_lshlrev_b32 v5, 4, v2
    s_waitcnt lgkmcnt(0)
    s_cmp_eq_u32 s28, 0
    s_cbranch_scc1 K1_CW
    s_cmp_eq_u32 s28, 1
    s_cbranch_scc1 K1_CG
    s_cmp_gt_u32 s28, 5
    s_cbranch_scc1 K1_END
    s_mov_b32 s12, s44
    s_mov_b32 s13, s45
    s_mov_b32 s14, 0x2000
    s_mov_b32 s15, 0x20000
    s_sub_u32 s29, s28, 2
    s_lshl_b32 s30, s29, 11
    v_lshlrev_b32 v6, 10, v4
    v_lshl_add_u32 v6, v3, 2, v6
    buffer_load_dword v8, v6, s[12:15], s30 offen offset:0
    buffer_load_dword v9, v6, s[12:15], s30 offen offset:128
    buffer_load_dword v10, v6, s[12:15], s30 offen offset:256
    buffer_load_dword v11, v6, s[12:15], s30 offen offset:384
    buffer_load_dword v12, v6, s[12:15], s30 offen offset:512
    buffer_load_dword v13, v6, s[12:15], s30 offen offset:640
    buffer_load_dword v14, v6, s[12:15], s30 offen offset:768
    buffer_load_dword v15, v6, s[12:15], s30 offen offset:896
    s_mov_b32 s32, 0x05040100
    s_mov_b32 s33, 0x07060302
    s_lshl_b32 s34, s29, 11
    s_add_u32 s34, s34, 0x7c1800
    s_waitcnt vmcnt(0)
    v_perm_b32 v16, v9, v8, s32
    v_perm_b32 v20, v9, v8, s33
    v_perm_b32 v17, v11, v10, s32
    v_perm_b32 v21, v11, v10, s33
    v_perm_b32 v18, v13, v12, s32
    v_perm_b32 v22, v13, v12, s33
    v_perm_b32 v19, v15, v14, s32
    v_perm_b32 v23, v15, v14, s33
    buffer_store_dwordx4 v[16:19], v5, s[24:27], s34 offen
    buffer_store_dwordx4 v[20:23], v5, s[24:27], s34 offen offset:1024
    s_endpgm
K1_CG:
    s_mov_b32 s12, s42
    s_mov_b32 s13, s43
    s_mov_b32 s14, 0x80
    s_mov_b32 s15, 0x20000
    v_and_b32 v6, 3, v0
    v_lshlrev_b32 v6, 1, v6
    buffer_load_ushort v8, v6, s[12:15], 0 offen offset:0
    buffer_load_ushort v9, v6, s[12:15], 0 offen offset:8
    buffer_load_ushort v10, v6, s[12:15], 0 offen offset:16
    buffer_load_ushort v11, v6, s[12:15], 0 offen offset:24
    buffer_load_ushort v12, v6, s[12:15], 0 offen offset:32
    buffer_load_ushort v13, v6, s[12:15], 0 offen offset:40
    buffer_load_ushort v14, v6, s[12:15], 0 offen offset:48
    buffer_load_ushort v15, v6, s[12:15], 0 offen offset:56
    buffer_load_ushort v16, v6, s[12:15], 0 offen offset:64
    buffer_load_ushort v17, v6, s[12:15], 0 offen offset:72
    buffer_load_ushort v18, v6, s[12:15], 0 offen offset:80
    buffer_load_ushort v19, v6, s[12:15], 0 offen offset:88
    buffer_load_ushort v20, v6, s[12:15], 0 offen offset:96
    buffer_load_ushort v21, v6, s[12:15], 0 offen offset:104
    buffer_load_ushort v22, v6, s[12:15], 0 offen offset:112
    buffer_load_ushort v23, v6, s[12:15], 0 offen offset:120
    s_mov_b32 s34, 0x7c1000
    s_waitcnt vmcnt(0)
    v_lshl_or_b32 v24, v9, 16, v8
    v_lshl_or_b32 v25, v11, 16, v10
    v_lshl_or_b32 v26, v13, 16, v12
    v_lshl_or_b32 v27, v15, 16, v14
    v_lshl_or_b32 v28, v17, 16, v16
    v_lshl_or_b32 v29, v19, 16, v18
    v_lshl_or_b32 v30, v21, 16, v20
    v_lshl_or_b32 v31, v23, 16, v22
    buffer_store_dwordx4 v[24:27], v5, s[24:27], s34 offen
    buffer_store_dwordx4 v[28:31], v5, s[24:27], s34 offen offset:1024
    s_endpgm
K1_CW:
    s_mov_b32 s12, s40
    s_mov_b32 s13, s41
    s_mov_b32 s14, 0x800
    s_mov_b32 s15, 0x20000
    v_lshlrev_b32 v6, 10, v4
    v_lshl_add_u32 v6, v3, 2, v6
    buffer_load_dword v8, v6, s[12:15], 0 offen offset:0
    buffer_load_dword v9, v6, s[12:15], 0 offen offset:128
    buffer_load_dword v10, v6, s[12:15], 0 offen offset:256
    buffer_load_dword v11, v6, s[12:15], 0 offen offset:384
    buffer_load_dword v12, v6, s[12:15], 0 offen offset:512
    buffer_load_dword v13, v6, s[12:15], 0 offen offset:640
    buffer_load_dword v14, v6, s[12:15], 0 offen offset:768
    buffer_load_dword v15, v6, s[12:15], 0 offen offset:896
    s_mov_b32 s30, 0xbfb8aa3b
    s_mov_b32 s31, 0xffff0000
    s_mov_b32 s34, 0x7c0000
    s_waitcnt vmcnt(0)
    v_lshlrev_b32 v16, 16, v8
    v_lshlrev_b32 v17, 16, v9
    v_lshlrev_b32 v18, 16, v10
    v_lshlrev_b32 v19, 16, v11
    v_lshlrev_b32 v20, 16, v12
    v_lshlrev_b32 v21, 16, v13
    v_lshlrev_b32 v22, 16, v14
    v_lshlrev_b32 v23, 16, v15
    v_mul_f32 v24, s30, v16
    v_mul_f32 v25, s30, v17
    v_mul_f32 v26, s30, v18
    v_mul_f32 v27, s30, v19
    v_mul_f32 v28, s30, v20
    v_mul_f32 v29, s30, v21
    v_mul_f32 v30, s30, v22
    v_mul_f32 v31, s30, v23
    v_cvt_pk_bf16_f32 v32, v24, v25
    v_cvt_pk_bf16_f32 v33, v26, v27
    v_cvt_pk_bf16_f32 v34, v28, v29
    v_cvt_pk_bf16_f32 v35, v30, v31
    v_lshlrev_b32 v24, 16, v32
    v_and_b32 v25, s31, v32
    v_lshlrev_b32 v26, 16, v33
    v_and_b32 v27, s31, v33
    v_lshlrev_b32 v28, 16, v34
    v_and_b32 v29, s31, v34
    v_lshlrev_b32 v30, 16, v35
    v_and_b32 v31, s31, v35
    v_fma_f32 v24, v16, s30, -v24
    v_fma_f32 v25, v17, s30, -v25
    v_fma_f32 v26, v18, s30, -v26
    v_fma_f32 v27, v19, s30, -v27
    v_fma_f32 v28, v20, s30, -v28
    v_fma_f32 v29, v21, s30, -v29
    v_fma_f32 v30, v22, s30, -v30
    v_fma_f32 v31, v23, s30, -v31
    v_cvt_pk_bf16_f32 v36, v24, v25
    v_cvt_pk_bf16_f32 v37, v26, v27
    v_cvt_pk_bf16_f32 v38, v28, v29
    v_cvt_pk_bf16_f32 v39, v30, v31
    buffer_store_dwordx4 v[32:35], v5, s[24:27], s34 offen offset:0
    buffer_store_dwordx4 v[36:39], v5, s[24:27], s34 offen offset:1024
    s_waitcnt vmcnt(0)
    v_and_b32 v16, s31, v8
    v_and_b32 v17, s31, v9
    v_and_b32 v18, s31, v10
    v_and_b32 v19, s31, v11
    v_and_b32 v20, s31, v12
    v_and_b32 v21, s31, v13
    v_and_b32 v22, s31, v14
    v_and_b32 v23, s31, v15
    v_mul_f32 v24, s30, v16
    v_mul_f32 v25, s30, v17
    v_mul_f32 v26, s30, v18
    v_mul_f32 v27, s30, v19
    v_mul_f32 v28, s30, v20
    v_mul_f32 v29, s30, v21
    v_mul_f32 v30, s30, v22
    v_mul_f32 v31, s30, v23
    v_cvt_pk_bf16_f32 v40, v24, v25
    v_cvt_pk_bf16_f32 v41, v26, v27
    v_cvt_pk_bf16_f32 v42, v28, v29
    v_cvt_pk_bf16_f32 v43, v30, v31
    v_lshlrev_b32 v24, 16, v40
    v_and_b32 v25, s31, v40
    v_lshlrev_b32 v26, 16, v41
    v_and_b32 v27, s31, v41
    v_lshlrev_b32 v28, 16, v42
    v_and_b32 v29, s31, v42
    v_lshlrev_b32 v30, 16, v43
    v_and_b32 v31, s31, v43
    v_fma_f32 v24, v16, s30, -v24
    v_fma_f32 v25, v17, s30, -v25
    v_fma_f32 v26, v18, s30, -v26
    v_fma_f32 v27, v19, s30, -v27
    v_fma_f32 v28, v20, s30, -v28
    v_fma_f32 v29, v21, s30, -v29
    v_fma_f32 v30, v22, s30, -v30
    v_fma_f32 v31, v23, s30, -v31
    v_cvt_pk_bf16_f32 v44, v24, v25
    v_cvt_pk_bf16_f32 v45, v26, v27
    v_cvt_pk_bf16_f32 v46, v28, v29
    v_cvt_pk_bf16_f32 v47, v30, v31
    buffer_store_dwordx4 v[40:43], v5, s[24:27], s34 offen offset:2048
    buffer_store_dwordx4 v[44:47], v5, s[24:27], s34 offen offset:3072
    s_waitcnt vmcnt(0)
    s_endpgm
.p2align 12
.globl gather_scatter__tensor_product_equiv_tfn__graph_kernel
.p2align 8
.type gather_scatter__tensor_product_equiv_tfn__graph_kernel,@function
gather_scatter__tensor_product_equiv_tfn__graph_kernel:
    s_cmp_lt_u32 s2, 256
    s_cbranch_scc1 K2_GO
    s_endpgm
K2_Wa:
    s_branch K1_BACK
K2_GO:
    s_load_dwordx2 s[24:25], s[0:1], 80
    s_load_dwordx2 s[12:13], s[0:1], 0
    s_load_dwordx2 s[16:17], s[0:1], 32
    s_load_dwordx2 s[20:21], s[0:1], 64
    v_lshrrev_b32 v32, 6, v0
    v_and_b32 v1, 63, v0
    v_readfirstlane_b32 s28, v32
    s_and_b32 s74, s2, 7
    s_lshl_b32 s74, s74, 5
    s_lshr_b32 s75, s2, 3
    s_add_u32 s29, s74, s75
    s_mov_b32 s26, 0x7f3900
    s_mov_b32 s27, 0x20000
    v_lshrrev_b32 v32, 4, v1
    v_lshrrev_b32 v33, 1, v1
    s_lshl_b32 s74, s28, 15
    s_lshl_b32 s75, s29, 2
    v_lshlrev_b32 v32, 13, v32
    v_lshlrev_b32 v33, 10, v33
    s_add_u32 s74, s74, s75
    s_add_u32 s74, s74, 0x780000
    s_add_u32 s75, s74, 4096
    v_lshlrev_b32 v40, 4, v1
    s_lshl_b32 s76, s28, 10
    s_add_u32 s76, s76, 0x7c1800
    s_mov_b32 s14, 0x4e2000
    s_mov_b32 s15, 0x20000
    s_mov_b32 s18, 0x1388000
    s_mov_b32 s19, 0x20000
    s_mov_b32 s22, 0x4e2000
    s_mov_b32 s23, 0x20000
    s_mov_b32 s32, 0
    s_movk_i32 s33, 384
    s_waitcnt lgkmcnt(0)
    buffer_load_dword v8, v32, s[24:27], s74 offen offset:0
    buffer_load_dword v9, v32, s[24:27], s74 offen offset:1024
    buffer_load_dword v10, v32, s[24:27], s74 offen offset:2048
    buffer_load_dword v11, v32, s[24:27], s74 offen offset:3072
    buffer_load_dword v12, v32, s[24:27], s75 offen offset:0
    buffer_load_dword v13, v32, s[24:27], s75 offen offset:1024
    buffer_load_dword v14, v32, s[24:27], s75 offen offset:2048
    buffer_load_dword v15, v32, s[24:27], s75 offen offset:3072
    buffer_load_dword v16, v33, s[24:27], s74 offen
    buffer_load_dwordx4 v[236:239], v40, s[24:27], s76 offen
    s_mov_b32 s74, 0x7c0000
    buffer_load_dwordx4 v[160:163], v40, s[24:27], s74 offen offset:0
    buffer_load_dwordx4 v[164:167], v40, s[24:27], s74 offen offset:1024
    buffer_load_dwordx4 v[168:171], v40, s[24:27], s74 offen offset:2048
    buffer_load_dwordx4 v[172:175], v40, s[24:27], s74 offen offset:3072
    s_mov_b32 s74, 0x7c1000
    buffer_load_dwordx4 v[176:179], v40, s[24:27], s74 offen offset:0
    buffer_load_dwordx4 v[180:183], v40, s[24:27], s74 offen offset:1024
    s_mul_i32 s4, s28, 983040
    s_add_u32 s5, s4, 30720
    s_add_u32 s6, s5, 30720
    s_add_u32 s7, s6, 30720
    s_add_u32 s8, s7, 30720
    s_add_u32 s9, s8, 30720
    s_add_u32 s10, s9, 30720
    s_add_u32 s11, s10, 30720
K2_ROUND:
    v_lshlrev_b32 v7, 2, v1
    v_mov_b32 v5, 1
    v_mov_b64 v[36:37], 0
    v_mov_b32 v38, 0x3fff
    v_mov_b32 v39, 0x40000000
    v_lshlrev_b32 v35, 4, v0
    ds_write2st64_b32 v7, v5, v5 offset0:0 offset1:1
    ds_write2st64_b32 v7, v5, v5 offset0:2 offset1:3
    ds_write2st64_b32 v7, v5, v36 offset0:4 offset1:16
    v_add_u32 v35, 35584, v35
    v_and_b32 v2, 15, v1
    v_lshrrev_b32 v40, 4, v1
    v_mad_u32_u24 v2, v2, 12, s32
    v_mul_u32_u24 v3, 245760, v40
    v_and_b32 v4, 1, v1
    v_lshrrev_b32 v41, 1, v1
    v_add_u32 v3, v3, v2
    s_add_u32 s74, s32, 192
    v_mad_u32_u24 v4, v4, 12, s74
    v_mul_u32_u24 v6, 30720, v41
    s_add_u32 s76, s32, s33
    v_add_u32 v6, v6, v4
    ds_write_b128 v35, v[36:39] offset:0
    ds_write_b128 v35, v[36:39] offset:8192
    ds_write_b128 v35, v[36:39] offset:16384
    ds_write_b128 v35, v[36:39] offset:24576
    ds_write_b128 v35, v[36:39] offset:32768
    ds_write_b128 v35, v[36:39] offset:40960
    ds_write_b128 v35, v[36:39] offset:49152
    ds_write_b128 v35, v[36:39] offset:57344
    v_add_u32 v35, 0x10000, v35
    ds_write_b128 v35, v[36:39] offset:0
    s_mov_b64 s[58:59], 0
    s_mov_b64 s[60:61], 0
    s_mov_b64 s[62:63], 0
    s_mov_b64 s[64:65], 0
    s_mov_b64 s[66:67], 0
    s_mov_b64 s[68:69], 0
    s_mov_b64 s[70:71], 0
    s_waitcnt vmcnt(7)
    v_add_u32_sdwa v24, v3, v8 dst_sel:DWORD dst_unused:UNUSED_PAD src0_sel:DWORD src1_sel:WORD_0
    v_cmp_lt_u32_sdwa s[40:41], v2, v8 src0_sel:DWORD src1_sel:WORD_1
    v_add_u32_sdwa v25, v3, v9 dst_sel:DWORD dst_unused:UNUSED_PAD src0_sel:DWORD src1_sel:WORD_0
    v_cmp_lt_u32_sdwa s[42:43], v2, v9 src0_sel:DWORD src1_sel:WORD_1
    v_add_u32_sdwa v26, v3, v10 dst_sel:DWORD dst_unused:UNUSED_PAD src0_sel:DWORD src1_sel:WORD_0
    v_cmp_lt_u32_sdwa s[44:45], v2, v10 src0_sel:DWORD src1_sel:WORD_1
    v_add_u32_sdwa v27, v3, v11 dst_sel:DWORD dst_unused:UNUSED_PAD src0_sel:DWORD src1_sel:WORD_0
    v_cmp_lt_u32_sdwa s[46:47], v2, v11 src0_sel:DWORD src1_sel:WORD_1
    s_or_b64 exec, s[40:41], 1
    buffer_load_dwordx3 v[64:66], v24, s[24:27], s4 offen
    s_or_b64 exec, s[42:43], 1
    buffer_load_dwordx3 v[68:70], v25, s[24:27], s5 offen
    s_or_b64 exec, s[44:45], 1
    buffer_load_dwordx3 v[72:74], v26, s[24:27], s6 offen
    s_or_b64 exec, s[46:47], 1
    buffer_load_dwordx3 v[76:78], v27, s[24:27], s7 offen
    s_mov_b64 exec, -1
    v_add_u32_sdwa v28, v3, v12 dst_sel:DWORD dst_unused:UNUSED_PAD src0_sel:DWORD src1_sel:WORD_0
    v_cmp_lt_u32_sdwa s[48:49], v2, v12 src0_sel:DWORD src1_sel:WORD_1
    v_add_u32_sdwa v29, v3, v13 dst_sel:DWORD dst_unused:UNUSED_PAD src0_sel:DWORD src1_sel:WORD_0
    v_cmp_lt_u32_sdwa s[50:51], v2, v13 src0_sel:DWORD src1_sel:WORD_1
    v_add_u32_sdwa v30, v3, v14 dst_sel:DWORD dst_unused:UNUSED_PAD src0_sel:DWORD src1_sel:WORD_0
    v_cmp_lt_u32_sdwa s[52:53], v2, v14 src0_sel:DWORD src1_sel:WORD_1
    v_add_u32_sdwa v31, v3, v15 dst_sel:DWORD dst_unused:UNUSED_PAD src0_sel:DWORD src1_sel:WORD_0
    v_cmp_lt_u32_sdwa s[54:55], v2, v15 src0_sel:DWORD src1_sel:WORD_1
    v_add_u32_sdwa v6, v6, v16 dst_sel:DWORD dst_unused:UNUSED_PAD src0_sel:DWORD src1_sel:WORD_0
    v_cmp_lt_u32_sdwa s[56:57], v4, v16 src0_sel:DWORD src1_sel:WORD_1
    v_cmp_lt_u32_sdwa s[72:73], s76, v16 src0_sel:DWORD src1_sel:WORD_1
    s_or_b64 exec, s[48:49], 1
    buffer_load_dwordx3 v[80:82], v28, s[24:27], s8 offen
    s_or_b64 exec, s[50:51], 1
    buffer_load_dwordx3 v[84:86], v29, s[24:27], s9 offen
    s_or_b64 exec, s[52:53], 1
    buffer_load_dwordx3 v[88:90], v30, s[24:27], s10 offen
    s_or_b64 exec, s[54:55], 1
    buffer_load_dwordx3 v[92:94], v31, s[24:27], s11 offen
    s_cmpk_eq_u32 s33, 384
    s_cselect_b64 s[56:57], s[56:57], 0
    s_mov_b64 exec, s[56:57]
    s_cbranch_execz K2_SL
    buffer_load_dwordx3 v[96:98], v6, s[24:27], s4 offen offset:0
    v_add_u32 v4, 24, v4
    v_cmp_lt_u32_sdwa s[58:59], v4, v16 src0_sel:DWORD src1_sel:WORD_1
    s_mov_b64 exec, s[58:59]
    s_cbranch_execz K2_SL
    buffer_load_dwordx3 v[100:102], v6, s[24:27], s4 offen offset:24
    v_add_u32 v4, 24, v4
    v_cmp_lt_u32_sdwa s[60:61], v4, v16 src0_sel:DWORD src1_sel:WORD_1
    s_mov_b64 exec, s[60:61]
    s_cbranch_execz K2_SL
    buffer_load_dwordx3 v[104:106], v6, s[24:27], s4 offen offset:48
    v_add_u32 v4, 24, v4
    v_cmp_lt_u32_sdwa s[62:63], v4, v16 src0_sel:DWORD src1_sel:WORD_1
    s_mov_b64 exec, s[62:63]
    s_cbranch_execz K2_SL
    buffer_load_dwordx3 v[108:110], v6, s[24:27], s4 offen offset:72
    v_add_u32 v4, 24, v4
    v_cmp_lt_u32_sdwa s[64:65], v4, v16 src0_sel:DWORD src1_sel:WORD_1
    s_mov_b64 exec, s[64:65]
    s_cbranch_execz K2_SL
    buffer_load_dwordx3 v[112:114], v6, s[24:27], s4 offen offset:96
    v_add_u32 v4, 24, v4
    v_cmp_lt_u32_sdwa s[66:67], v4, v16 src0_sel:DWORD src1_sel:WORD_1
    s_mov_b64 exec, s[66:67]
    s_cbranch_execz K2_SL
    buffer_load_dwordx3 v[116:118], v6, s[24:27], s4 offen offset:120
    v_add_u32 v4, 24, v4
    v_cmp_lt_u32_sdwa s[68:69], v4, v16 src0_sel:DWORD src1_sel:WORD_1
    s_mov_b64 exec, s[68:69]
    s_cbranch_execz K2_SL
    buffer_load_dwordx3 v[120:122], v6, s[24:27], s4 offen offset:144
    v_add_u32 v4, 24, v4
    v_cmp_lt_u32_sdwa s[70:71], v4, v16 src0_sel:DWORD src1_sel:WORD_1
    s_mov_b64 exec, s[70:71]
    s_cbranch_execz K2_SL
    buffer_load_dwordx3 v[124:126], v6, s[24:27], s4 offen offset:168
K2_SL:
    s_mov_b64 exec, -1
    s_waitcnt lgkmcnt(0)
    s_barrier
    s_lshr_b32 s75, s2, 3
    s_mul_i32 s75, s75, 16384
    s_mul_i32 s35, s2, 18048
    s_add_u32 s35, s35, 507904
    s_cmp_lt_u32 s28, 2
    s_cselect_b32 s75, s75, s35
    v_lshlrev_b32 v34, 7, v0
    v_min_u32 v34, 34304, v34
    buffer_load_dword v231, v34, s[12:15], s75 offen
    s_cmp_eq_u64 s[72:73], 0
    s_cbranch_scc1 K2_NOFLAG
    ds_write_b32 v7, v5 offset:4096
K2_NOFLAG:
    s_mul_i32 s74, s28, 2560000
    v_mul_u32_u24 v67, 640000, v40
    v_mul_u32_u24 v17, 80000, v41
    v_add_u32 v67, s74, v67
    v_add_u32 v17, s74, v17
    v_add_u32 v71, 80000, v67
    v_add_u32 v75, 160000, v67
    v_add_u32 v79, 240000, v67
    v_add_u32 v83, 320000, v67
    v_add_u32 v87, 400000, v67
    v_add_u32 v91, 480000, v67
    v_add_u32 v95, 560000, v67
    v_mov_b64 v[144:145], 0
    v_mov_b64 v[146:147], 0
    v_mov_b64 v[148:149], 0
    v_mov_b64 v[150:151], 0
    s_cmp_lg_u32 s32, 0
    s_cbranch_scc1 K2_LATER
    v_mov_b64 v[184:185], 0
    v_mov_b64 v[186:187], 0
    v_mov_b64 v[188:189], 0
    v_mov_b64 v[190:191], 0
    v_mov_b64 v[192:193], 0
    v_mov_b64 v[194:195], 0
    v_mov_b64 v[196:197], 0
    v_mov_b64 v[198:199], 0
    v_mov_b64 v[200:201], 0
    v_mov_b64 v[202:203], 0
    v_mov_b64 v[204:205], 0
    v_mov_b64 v[206:207], 0
    v_mov_b64 v[208:209], 0
    v_mov_b64 v[210:211], 0
    v_mov_b64 v[212:213], 0
    v_mov_b64 v[214:215], 0
    v_mov_b64 v[216:217], 0
    v_mov_b64 v[218:219], 0
    v_mov_b64 v[220:221], 0
    v_mov_b64 v[222:223], 0
    s_mul_i32 s30, s29, 160069
    s_add_u32 s30, s30, 4095
    s_add_u32 s31, s30, 160069
    s_lshr_b32 s30, s30, 12
    s_lshr_b32 s31, s31, 12
    s_min_u32 s31, s31, 10000
    s_sub_u32 s31, s31, s30
    v_and_b32 v40, 31, v1
    v_lshlrev_b32 v224, 4, v40
    v_lshrrev_b32 v41, 5, v1
    v_lshlrev_b32 v225, 4, v41
    v_and_b32 v42, 15, v1
    v_lshl_add_u32 v226, v42, 5, v225
    v_and_b32 v227, 24, v1
    v_and_b32 v43, 3, v1
    v_lshl_add_u32 v227, v43, 1, v227
    v_bfe_u32 v43, v1, 2, 1
    v_add_lshl_u32 v227, v227, v43, 4
    v_and_b32 v43, 1, v1
    v_lshl_add_u32 v228, v43, 8, v225
    v_bfe_u32 v43, v1, 2, 3
    v_lshl_add_u32 v228, v43, 5, v228
    v_and_b32 v42, 7, v1
    v_cmp_eq_u32 vcc, 7, v42
    v_lshl_add_u32 v229, v42, 2, 1
    v_lshlrev_b32 v40, 4, v0
    v_cndmask_b32 v230, 0, 32, vcc
    s_waitcnt vmcnt(9)
    ds_write_b128 v40, v[236:239] offset:4352
K2_LATER:
    s_mov_b64 exec, s[40:41]
    s_waitcnt vmcnt(8)
    v_lshrrev_b32 v144, 9, v66
    v_and_b32 v144, 0x7fc, v144
    ds_add_rtn_u32 v128, v144, v5 offset:0
    s_mov_b64 exec, s[42:43]
    s_waitcnt vmcnt(7)
    v_lshrrev_b32 v145, 9, v70
    v_and_b32 v145, 0x7fc, v145
    ds_add_rtn_u32 v129, v145, v5 offset:0
    s_mov_b64 exec, s[44:45]
    s_waitcnt vmcnt(6)
    v_lshrrev_b32 v146, 9, v74
    v_and_b32 v146, 0x7fc, v146
    ds_add_rtn_u32 v130, v146, v5 offset:0
    s_mov_b64 exec, s[46:47]
    s_waitcnt vmcnt(5)
    v_lshrrev_b32 v147, 9, v78
    v_and_b32 v147, 0x7fc, v147
    ds_add_rtn_u32 v131, v147, v5 offset:0
    s_mov_b64 exec, s[48:49]
    s_waitcnt vmcnt(4)
    v_lshrrev_b32 v148, 9, v82
    v_and_b32 v148, 0x7fc, v148
    ds_add_rtn_u32 v132, v148, v5 offset:0
    s_mov_b64 exec, s[50:51]
    s_waitcnt vmcnt(3)
    v_lshrrev_b32 v149, 9, v86
    v_and_b32 v149, 0x7fc, v149
    ds_add_rtn_u32 v133, v149, v5 offset:0
    s_mov_b64 exec, s[52:53]
    s_waitcnt vmcnt(2)
    v_lshrrev_b32 v150, 9, v90
    v_and_b32 v150, 0x7fc, v150
    ds_add_rtn_u32 v134, v150, v5 offset:0
    s_mov_b64 exec, s[54:55]
    s_waitcnt vmcnt(1)
    v_lshrrev_b32 v151, 9, v94
    v_and_b32 v151, 0x7fc, v151
    ds_add_rtn_u32 v135, v151, v5 offset:0
    s_mov_b64 exec, s[56:57]
    s_cbranch_execz K2_SH
    s_waitcnt vmcnt(1)
    v_lshrrev_b32 v152, 9, v98
    v_and_b32 v152, 0x7fc, v152
    ds_add_rtn_u32 v136, v152, v5 offset:0
    v_mad_u32_u16 v99, v98, 2, v17 op_sel:[1,0,0,0]
    s_mov_b64 exec, s[58:59]
    s_cbranch_execz K2_SH
    v_lshrrev_b32 v153, 9, v102
    v_and_b32 v153, 0x7fc, v153
    ds_add_rtn_u32 v137, v153, v5 offset:0
    v_mad_u32_u16 v103, v102, 2, v17 op_sel:[1,0,0,0]
    s_mov_b64 exec, s[60:61]
    s_cbranch_execz K2_SH
    v_lshrrev_b32 v154, 9, v106
    v_and_b32 v154, 0x7fc, v154
    ds_add_rtn_u32 v138, v154, v5 offset:0
    v_mad_u32_u16 v107, v106, 2, v17 op_sel:[1,0,0,0]
    s_mov_b64 exec, s[62:63]
    s_cbranch_execz K2_SH
    v_lshrrev_b32 v155, 9, v110
    v_and_b32 v155, 0x7fc, v155
    ds_add_rtn_u32 v139, v155, v5 offset:0
    v_mad_u32_u16 v111, v110, 2, v17 op_sel:[1,0,0,0]
    s_mov_b64 exec, s[64:65]
    s_cbranch_execz K2_SH
    v_lshrrev_b32 v156, 9, v114
    v_and_b32 v156, 0x7fc, v156
    ds_add_rtn_u32 v140, v156, v5 offset:0
    v_mad_u32_u16 v115, v114, 2, v17 op_sel:[1,0,0,0]
    s_mov_b64 exec, s[66:67]
    s_cbranch_execz K2_SH
    v_lshrrev_b32 v157, 9, v118
    v_and_b32 v157, 0x7fc, v157
    ds_add_rtn_u32 v141, v157, v5 offset:0
    v_mad_u32_u16 v119, v118, 2, v17 op_sel:[1,0,0,0]
    s_mov_b64 exec, s[68:69]
    s_cbranch_execz K2_SH
    v_lshrrev_b32 v158, 9, v122
    v_and_b32 v158, 0x7fc, v158
    ds_add_rtn_u32 v142, v158, v5 offset:0
    v_mad_u32_u16 v123, v122, 2, v17 op_sel:[1,0,0,0]
    s_mov_b64 exec, s[70:71]
    s_cbranch_execz K2_SH
    v_lshrrev_b32 v159, 9, v126
    v_and_b32 v159, 0x7fc, v159
    ds_add_rtn_u32 v143, v159, v5 offset:0
    v_mad_u32_u16 v127, v126, 2, v17 op_sel:[1,0,0,0]
K2_SH:
    s_mov_b64 exec, -1
    v_mad_u32_u16 v67, v66, 2, v67 op_sel:[1,0,0,0]
    v_mad_u32_u16 v71, v70, 2, v71 op_sel:[1,0,0,0]
    v_mad_u32_u16 v75, v74, 2, v75 op_sel:[1,0,0,0]
    v_mad_u32_u16 v79, v78, 2, v79 op_sel:[1,0,0,0]
    v_mad_u32_u16 v83, v82, 2, v83 op_sel:[1,0,0,0]
    v_mad_u32_u16 v87, v86, 2, v87 op_sel:[1,0,0,0]
    v_mad_u32_u16 v91, v90, 2, v91 op_sel:[1,0,0,0]
    v_mad_u32_u16 v95, v94, 2, v95 op_sel:[1,0,0,0]
    s_lshl_b32 s74, s28, 3
    s_add_u32 s75, s74, 7
    s_waitcnt lgkmcnt(0)
    s_barrier
    ds_read2st64_b32 v[34:35], v7 offset0:0 offset1:1
    ds_read2st64_b32 v[36:37], v7 offset0:2 offset1:3
    ds_read2st64_b32 v[38:39], v7 offset0:4 offset1:16
    s_waitcnt lgkmcnt(1)
    v_and_b32 v34, -2, v34
    v_and_b32 v35, -2, v35
    v_and_b32 v36, -2, v36
    v_and_b32 v37, -2, v37
    v_add_u32 v41, v34, v35
    s_waitcnt lgkmcnt(0)
    v_and_b32 v38, -2, v38
    v_add_u32 v42, v41, v36
    v_add_u32 v38, v38, v230
    v_add_u32 v43, v42, v37
    v_add_u32 v50, v43, v38
    v_readfirstlane_b32 s34, v39
    v_add3_u32 v51, v43, v38, 1
    v_add_u32_dpp v44, v50, v50 row_shr:1 row_mask:0xf bank_mask:0xf bound_ctrl:0
    s_nop 1
    v_add_u32_dpp v44, v44, v44 row_shr:2 row_mask:0xf bank_mask:0xf bound_ctrl:0
    s_nop 1
    v_add_u32_dpp v44, v44, v44 row_shr:4 row_mask:0xf bank_mask:0xf bound_ctrl:0
    s_nop 1
    v_add_u32_dpp v44, v44, v44 row_shr:8 row_mask:0xf bank_mask:0xf bound_ctrl:0
    s_nop 1
    v_add_u32_dpp v44, v44, v44 row_bcast:15 row_mask:0xa bank_mask:0xf
    s_nop 1
    v_add_u32_dpp v44, v44, v44 row_bcast:31 row_mask:0xc bank_mask:0xf
    s_nop 0
    v_readlane_b32 s35, v44, 63
    v_sub_u32 v44, v44, v51
    v_add_u32 v45, v44, v34
    v_add_u32 v46, v44, v41
    v_add_u32 v47, v44, v42
    v_add_u32 v48, v44, v43
    s_cmp_gt_u32 s35, 4552
    s_cbranch_scc1 K2_NARROW
    ds_write2st64_b32 v7, v44, v45 offset0:8 offset1:9
    ds_write2st64_b32 v7, v46, v47 offset0:10 offset1:11
    ds_write_b32 v7, v48 offset:3072
    ds_read_b32 v144, v144 offset:2048
    ds_read_b32 v145, v145 offset:2048
    ds_read_b32 v146, v146 offset:2048
    ds_read_b32 v147, v147 offset:2048
    ds_read_b32 v148, v148 offset:2048
    ds_read_b32 v149, v149 offset:2048
    ds_read_b32 v150, v150 offset:2048
    ds_read_b32 v151, v151 offset:2048
    s_mov_b64 exec, s[56:57]
    s_cbranch_execz K2_SO
    ds_read_b32 v152, v152 offset:2048
    s_mov_b64 exec, s[58:59]
    s_cbranch_execz K2_SO
    ds_read_b32 v153, v153 offset:2048
    s_mov_b64 exec, s[60:61]
    s_cbranch_execz K2_SO
    ds_read_b32 v154, v154 offset:2048
    s_mov_b64 exec, s[62:63]
    s_cbranch_execz K2_SO
    ds_read_b32 v155, v155 offset:2048
    s_mov_b64 exec, s[64:65]
    s_cbranch_execz K2_SO
    ds_read_b32 v156, v156 offset:2048
    s_mov_b64 exec, s[66:67]
    s_cbranch_execz K2_SO
    ds_read_b32 v157, v157 offset:2048
    s_mov_b64 exec, s[68:69]
    s_cbranch_execz K2_SO
    ds_read_b32 v158, v158 offset:2048
    s_mov_b64 exec, s[70:71]
    s_cbranch_execz K2_SO
    ds_read_b32 v159, v159 offset:2048
K2_SO:
    s_mov_b64 exec, -1
    v_readlane_b32 s36, v44, s74
    v_readlane_b32 s37, v44, s75
    s_add_u32 s36, s36, 1
    s_add_u32 s37, s37, 1
    s_lshl_b32 s74, s36, 4
    v_add_u32 v59, s74, v226
    v_add_u32 v60, s74, v227
    v_add_u32 v61, s74, v228
    s_waitcnt lgkmcnt(4)
    v_add_lshl_u32 v144, v144, v128, 4
    v_add_lshl_u32 v145, v145, v129, 4
    v_add_lshl_u32 v146, v146, v130, 4
    v_add_lshl_u32 v147, v147, v131, 4
    s_waitcnt lgkmcnt(0)
    v_add_lshl_u32 v148, v148, v132, 4
    v_add_lshl_u32 v149, v149, v133, 4
    v_add_lshl_u32 v150, v150, v134, 4
    v_add_lshl_u32 v151, v151, v135, 4
    s_mov_b64 exec, s[40:41]
    ds_write_b128 v144, v[64:67] offset:35584
    s_mov_b64 exec, s[42:43]
    ds_write_b128 v145, v[68:71] offset:35584
    s_mov_b64 exec, s[44:45]
    ds_write_b128 v146, v[72:75] offset:35584
    s_mov_b64 exec, s[46:47]
    ds_write_b128 v147, v[76:79] offset:35584
    s_mov_b64 exec, s[48:49]
    ds_write_b128 v148, v[80:83] offset:35584
    s_mov_b64 exec, s[50:51]
    ds_write_b128 v149, v[84:87] offset:35584
    s_mov_b64 exec, s[52:53]
    ds_write_b128 v150, v[88:91] offset:35584
    s_mov_b64 exec, s[54:55]
    ds_write_b128 v151, v[92:95] offset:35584
    s_mov_b64 exec, s[56:57]
    s_cbranch_execz K2_SP
    v_add_lshl_u32 v152, v152, v136, 4
    ds_write_b128 v152, v[96:99] offset:35584
    s_mov_b64 exec, s[58:59]
    s_cbranch_execz K2_SP
    v_add_lshl_u32 v153, v153, v137, 4
    ds_write_b128 v153, v[100:103] offset:35584
    s_mov_b64 exec, s[60:61]
    s_cbranch_execz K2_SP
    v_add_lshl_u32 v154, v154, v138, 4
    ds_write_b128 v154, v[104:107] offset:35584
    s_mov_b64 exec, s[62:63]
    s_cbranch_execz K2_SP
    v_add_lshl_u32 v155, v155, v139, 4
    ds_write_b128 v155, v[108:111] offset:35584
    s_mov_b64 exec, s[64:65]
    s_cbranch_execz K2_SP
    v_add_lshl_u32 v156, v156, v140, 4
    ds_write_b128 v156, v[112:115] offset:35584
    s_mov_b64 exec, s[66:67]
    s_cbranch_execz K2_SP
    v_add_lshl_u32 v157, v157, v141, 4
    ds_write_b128 v157, v[116:119] offset:35584
    s_mov_b64 exec, s[68:69]
    s_cbranch_execz K2_SP
    v_add_lshl_u32 v158, v158, v142, 4
    ds_write_b128 v158, v[120:123] offset:35584
    s_mov_b64 exec, s[70:71]
    s_cbranch_execz K2_SP
    v_add_lshl_u32 v159, v159, v143, 4
    ds_write_b128 v159, v[124:127] offset:35584
K2_SP:
    s_mov_b64 exec, -1
    s_waitcnt lgkmcnt(0)
    s_barrier
    s_cmp_ge_u32 s36, s37
    s_cbranch_scc1 K2_EMPTY
    ds_read_b32 v8, v60 offset:35596
    ds_read_b32 v9, v59 offset:35592
    ds_read_b64 v[50:51], v61 offset:35584
    ds_read_b32 v54, v59 offset:36104
    ds_read_b32 v55, v60 offset:36108
    s_waitcnt lgkmcnt(3)
    v_bfi_b32 v8, 31, v225, v8
    v_and_b32 v52, 0x3fff, v9
    v_lshlrev_b32 v52, 9, v52
    buffer_load_dwordx4 v[44:47], v8, s[16:19], 0 offen
    s_nop 0
    v_add_u32_dpp v56, v52, v224 row_newbcast:0 row_mask:0xf bank_mask:0xf
    buffer_load_dwordx4 v[64:67], v56, s[12:15], 0 offen
    v_add_u32_dpp v57, v52, v224 row_newbcast:1 row_mask:0xf bank_mask:0xf
    buffer_load_dwordx4 v[68:71], v57, s[12:15], 0 offen
    v_add_u32_dpp v56, v52, v224 row_newbcast:2 row_mask:0xf bank_mask:0xf
    buffer_load_dwordx4 v[72:75], v56, s[12:15], 0 offen
    v_add_u32_dpp v57, v52, v224 row_newbcast:3 row_mask:0xf bank_mask:0xf
    buffer_load_dwordx4 v[76:79], v57, s[12:15], 0 offen
    v_add_u32_dpp v56, v52, v224 row_newbcast:4 row_mask:0xf bank_mask:0xf
    buffer_load_dwordx4 v[80:83], v56, s[12:15], 0 offen
    v_add_u32_dpp v57, v52, v224 row_newbcast:5 row_mask:0xf bank_mask:0xf
    buffer_load_dwordx4 v[84:87], v57, s[12:15], 0 offen
    s_waitcnt lgkmcnt(0)
    v_mfma_f32_4x4x4_16b_bf16 v[24:27], v[50:51], v[176:177], 0
    v_mfma_f32_4x4x4_16b_bf16 v[28:31], v[50:51], v[178:179], 0
    v_mfma_f32_4x4x4_16b_bf16 v[32:35], v[50:51], v[180:181], 0
    v_mfma_f32_4x4x4_16b_bf16 v[36:39], v[50:51], v[182:183], 0
    v_and_b32 v53, 0x3fff, v54
    v_lshlrev_b32 v53, 9, v53
    v_bfi_b32 v55, 31, v225, v55
    v_bfe_u32 v10, v9, 17, 3
    v_bfe_u32 v58, v54, 17, 3
    v_lshlrev_b32 v10, v229, v10
    v_lshlrev_b32 v58, v229, v58
    s_nop 0
    v_or_b32_dpp v10, v10, v10 row_shr:1 row_mask:0xf bank_mask:0xf bound_ctrl:0
    v_or_b32_dpp v58, v58, v58 row_shr:1 row_mask:0xf bank_mask:0xf bound_ctrl:0
    s_nop 0
    v_or_b32_dpp v10, v10, v10 row_shr:2 row_mask:0xf bank_mask:0xf bound_ctrl:0
    v_or_b32_dpp v58, v58, v58 row_shr:2 row_mask:0xf bank_mask:0xf bound_ctrl:0
    s_nop 0
    v_or_b32_dpp v10, v10, v10 row_shr:4 row_mask:0xf bank_mask:0xf bound_ctrl:0
    v_or_b32_dpp v58, v58, v58 row_shr:4 row_mask:0xf bank_mask:0xf bound_ctrl:0
    s_nop 0
    v_cvt_pk_bf16_f32 v40, v24, v28
    v_cvt_pk_bf16_f32 v41, v32, v36
    v_cvt_pk_bf16_f32 v42, v25, v29
    v_cvt_pk_bf16_f32 v43, v33, v37
    v_readlane_b32 s40, v10, 7
    v_readlane_b32 s41, v10, 15
    v_readlane_b32 s42, v58, 7
    v_readlane_b32 s43, v58, 15
    s_waitcnt vmcnt(6)
    s_cmp_lt_u32 s28, 4
    s_cselect_b64 vcc, -1, 0
    s_setprio 1
    s_nop 0
    s_nop 0
    s_nop 0
    s_nop 0
    s_nop 0
    s_nop 0
    s_nop 0
    s_sub_u32 s77, s37, 32
    s_cmp_ge_i32 s36, s77
    s_cbranch_scc1 K2_LAST
    s_cbranch_vccz K2_TILE
K2_TILEH:
    s_setprio 2
    s_waitcnt vmcnt(16)
    v_mfma_f32_32x32x16_bf16 v[128:143], v[44:47], v[160:163], 0
    v_mfma_f32_32x32x16_bf16 v[128:143], v[44:47], v[164:167], v[128:143]
    v_mfma_f32_32x32x16_bf16 v[144:159], v[44:47], v[168:171], 0
    v_mfma_f32_32x32x16_bf16 v[144:159], v[44:47], v[172:175], v[144:159]
    buffer_load_dwordx4 v[44:47], v55, s[16:19], 0 offen
    ds_read_b32 v55, v60 offset:36620
    v_add_u32 v60, 512, v60
    ds_read_b64 v[50:51], v61 offset:36096
    ds_read_b32 v54, v59 offset:36616
    v_add_u32 v61, 512, v61
    v_add_u32 v59, 512, v59
    s_nop 3
    v_exp_f32 v48, v128
    v_exp_f32 v49, v129
    s_nop 0
    v_pk_add_f32 v[48:49], v[48:49], 1.0 op_sel_hi:[1,0]
    v_rcp_f32 v48, v48
    v_rcp_f32 v49, v49
    s_nop 0
    v_pk_mul_f32 v[128:129], v[128:129], v[48:49]
    s_waitcnt vmcnt(6)
    v_mfma_f32_4x4x4_16b_bf16 v[8:11], v[40:41], v[64:65], 0 cbsz:3 abid:0
    v_mfma_f32_4x4x4_16b_bf16 v[12:15], v[40:41], v[66:67], 0 cbsz:3 abid:0
    v_add_u32_dpp v56, v52, v224 row_newbcast:6 row_mask:0xf bank_mask:0xf
    v_exp_f32 v48, v144
    buffer_load_dwordx4 v[88:91], v56, s[12:15], 0 offen
    v_exp_f32 v49, v145
    s_nop 0
    v_pk_add_f32 v[48:49], v[48:49], 1.0 op_sel_hi:[1,0]
    v_rcp_f32 v48, v48
    v_rcp_f32 v49, v49
    s_nop 0
    v_pk_mul_f32 v[144:145], v[144:145], v[48:49]
    s_waitcnt vmcnt(6)
    v_mfma_f32_4x4x4_16b_bf16 v[16:19], v[40:41], v[68:69], 0 cbsz:3 abid:1
    v_mfma_f32_4x4x4_16b_bf16 v[20:23], v[40:41], v[70:71], 0 cbsz:3 abid:1
    v_add_u32_dpp v57, v52, v224 row_newbcast:7 row_mask:0xf bank_mask:0xf
    v_exp_f32 v48, v130
    buffer_load_dwordx4 v[92:95], v57, s[12:15], 0 offen
    v_exp_f32 v49, v131
    s_bfe_u32 s38, s40, 0x40000
    v_pk_add_f32 v[48:49], v[48:49], 1.0 op_sel_hi:[1,0]
    v_rcp_f32 v48, v48
    v_rcp_f32 v49, v49
    s_set_gpr_idx_on s38, gpr_idx(SRC2,DST)
    v_pk_fma_f32 v[184:185], v[8:9], v[128:129], v[184:185] op_sel:[0,0,0] op_sel_hi:[1,0,1]
    v_pk_fma_f32 v[194:195], v[10:11], v[128:129], v[194:195] op_sel:[0,0,0] op_sel_hi:[1,0,1]
    v_pk_fma_f32 v[204:205], v[12:13], v[144:145], v[204:205] op_sel:[0,0,0] op_sel_hi:[1,0,1]
    v_pk_fma_f32 v[214:215], v[14:15], v[144:145], v[214:215] op_sel:[0,0,0] op_sel_hi:[1,0,1]
    s_set_gpr_idx_off
    v_pk_mul_f32 v[130:131], v[130:131], v[48:49]
    s_waitcnt vmcnt(6)
    v_mfma_f32_4x4x4_16b_bf16 v[8:11], v[40:41], v[72:73], 0 cbsz:3 abid:2
    v_mfma_f32_4x4x4_16b_bf16 v[12:15], v[40:41], v[74:75], 0 cbsz:3 abid:2
    v_add_u32_dpp v56, v52, v224 row_newbcast:8 row_mask:0xf bank_mask:0xf
    v_exp_f32 v48, v146
    buffer_load_dwordx4 v[64:67], v56, s[12:15], 0 offen
    v_exp_f32 v49, v147
    s_bfe_u32 s38, s40, 0x40004
    v_pk_add_f32 v[48:49], v[48:49], 1.0 op_sel_hi:[1,0]
    v_rcp_f32 v48, v48
    v_rcp_f32 v49, v49
    s_set_gpr_idx_on s38, gpr_idx(SRC2,DST)
    v_pk_fma_f32 v[184:185], v[16:17], v[128:129], v[184:185] op_sel:[0,1,0] op_sel_hi:[1,1,1]
    v_pk_fma_f32 v[194:195], v[18:19], v[128:129], v[194:195] op_sel:[0,1,0] op_sel_hi:[1,1,1]
    v_pk_fma_f32 v[204:205], v[20:21], v[144:145], v[204:205] op_sel:[0,1,0] op_sel_hi:[1,1,1]
    v_pk_fma_f32 v[214:215], v[22:23], v[144:145], v[214:215] op_sel:[0,1,0] op_sel_hi:[1,1,1]
    s_set_gpr_idx_off
    v_pk_mul_f32 v[146:147], v[146:147], v[48:49]
    s_waitcnt vmcnt(6)
    v_mfma_f32_4x4x4_16b_bf16 v[16:19], v[40:41], v[76:77], 0 cbsz:3 abid:3
    v_mfma_f32_4x4x4_16b_bf16 v[20:23], v[40:41], v[78:79], 0 cbsz:3 abid:3
    v_add_u32_dpp v57, v52, v224 row_newbcast:9 row_mask:0xf bank_mask:0xf
    v_exp_f32 v48, v132
    buffer_load_dwordx4 v[68:71], v57, s[12:15], 0 offen
    v_exp_f32 v49, v133
    s_bfe_u32 s38, s40, 0x40008
    v_pk_add_f32 v[48:49], v[48:49], 1.0 op_sel_hi:[1,0]
    v_rcp_f32 v48, v48
    v_rcp_f32 v49, v49
    s_set_gpr_idx_on s38, gpr_idx(SRC2,DST)
    v_pk_fma_f32 v[184:185], v[8:9], v[130:131], v[184:185] op_sel:[0,0,0] op_sel_hi:[1,0,1]
    v_pk_fma_f32 v[194:195], v[10:11], v[130:131], v[194:195] op_sel:[0,0,0] op_sel_hi:[1,0,1]
    v_pk_fma_f32 v[204:205], v[12:13], v[146:147], v[204:205] op_sel:[0,0,0] op_sel_hi:[1,0,1]
    v_pk_fma_f32 v[214:215], v[14:15], v[146:147], v[214:215] op_sel:[0,0,0] op_sel_hi:[1,0,1]
    s_set_gpr_idx_off
    v_pk_mul_f32 v[132:133], v[132:133], v[48:49]
    s_waitcnt vmcnt(6)
    v_mfma_f32_4x4x4_16b_bf16 v[8:11], v[40:41], v[80:81], 0 cbsz:3 abid:4
    v_mfma_f32_4x4x4_16b_bf16 v[12:15], v[40:41], v[82:83], 0 cbsz:3 abid:4
    v_add_u32_dpp v56, v52, v224 row_newbcast:10 row_mask:0xf bank_mask:0xf
    v_exp_f32 v48, v148
    buffer_load_dwordx4 v[72:75], v56, s[12:15], 0 offen
    v_exp_f32 v49, v149
    s_bfe_u32 s38, s40, 0x4000c
    v_pk_add_f32 v[48:49], v[48:49], 1.0 op_sel_hi:[1,0]
    v_rcp_f32 v48, v48
    v_rcp_f32 v49, v49
    s_set_gpr_idx_on s38, gpr_idx(SRC2,DST)
    v_pk_fma_f32 v[184:185], v[16:17], v[130:131], v[184:185] op_sel:[0,1,0] op_sel_hi:[1,1,1]
    v_pk_fma_f32 v[194:195], v[18:19], v[130:131], v[194:195] op_sel:[0,1,0] op_sel_hi:[1,1,1]
    v_pk_fma_f32 v[204:205], v[20:21], v[146:147], v[204:205] op_sel:[0,1,0] op_sel_hi:[1,1,1]
    v_pk_fma_f32 v[214:215], v[22:23], v[146:147], v[214:215] op_sel:[0,1,0] op_sel_hi:[1,1,1]
    s_set_gpr_idx_off
    v_pk_mul_f32 v[148:149], v[148:149], v[48:49]
    s_waitcnt vmcnt(6)
    v_mfma_f32_4x4x4_16b_bf16 v[16:19], v[40:41], v[84:85], 0 cbsz:3 abid:5
    v_mfma_f32_4x4x4_16b_bf16 v[20:23], v[40:41], v[86:87], 0 cbsz:3 abid:5
    v_add_u32_dpp v57, v52, v224 row_newbcast:11 row_mask:0xf bank_mask:0xf
    v_exp_f32 v48, v134
    buffer_load_dwordx4 v[76:79], v57, s[12:15], 0 offen
    v_exp_f32 v49, v135
    s_bfe_u32 s38, s40, 0x40010
    v_pk_add_f32 v[48:49], v[48:49], 1.0 op_sel_hi:[1,0]
    v_rcp_f32 v48, v48
    v_rcp_f32 v49, v49
    s_set_gpr_idx_on s38, gpr_idx(SRC2,DST)
    v_pk_fma_f32 v[184:185], v[8:9], v[132:133], v[184:185] op_sel:[0,0,0] op_sel_hi:[1,0,1]
    v_pk_fma_f32 v[194:195], v[10:11], v[132:133], v[194:195] op_sel:[0,0,0] op_sel_hi:[1,0,1]
    v_pk_fma_f32 v[204:205], v[12:13], v[148:149], v[204:205] op_sel:[0,0,0] op_sel_hi:[1,0,1]
    v_pk_fma_f32 v[214:215], v[14:15], v[148:149], v[214:215] op_sel:[0,0,0] op_sel_hi:[1,0,1]
    s_set_gpr_idx_off
    v_pk_mul_f32 v[134:135], v[134:135], v[48:49]
    s_waitcnt vmcnt(5)
    v_mfma_f32_4x4x4_16b_bf16 v[8:11], v[40:41], v[88:89], 0 cbsz:3 abid:6
    v_mfma_f32_4x4x4_16b_bf16 v[12:15], v[40:41], v[90:91], 0 cbsz:3 abid:6
    v_add_u32_dpp v56, v52, v224 row_newbcast:12 row_mask:0xf bank_mask:0xf
    v_exp_f32 v48, v150
    buffer_load_dwordx4 v[80:83], v56, s[12:15], 0 offen
    v_exp_f32 v49, v151
    s_bfe_u32 s38, s40, 0x40014
    v_pk_add_f32 v[48:49], v[48:49], 1.0 op_sel_hi:[1,0]
    v_rcp_f32 v48, v48
    v_rcp_f32 v49, v49
    s_set_gpr_idx_on s38, gpr_idx(SRC2,DST)
    v_pk_fma_f32 v[184:185], v[16:17], v[132:133], v[184:185] op_sel:[0,1,0] op_sel_hi:[1,1,1]
    v_pk_fma_f32 v[194:195], v[18:19], v[132:133], v[194:195] op_sel:[0,1,0] op_sel_hi:[1,1,1]
    v_pk_fma_f32 v[204:205], v[20:21], v[148:149], v[204:205] op_sel:[0,1,0] op_sel_hi:[1,1,1]
    v_pk_fma_f32 v[214:215], v[22:23], v[148:149], v[214:215] op_sel:[0,1,0] op_sel_hi:[1,1,1]
    s_set_gpr_idx_off
    v_pk_mul_f32 v[150:151], v[150:151], v[48:49]
    s_waitcnt vmcnt(5)
    v_mfma_f32_4x4x4_16b_bf16 v[16:19], v[40:41], v[92:93], 0 cbsz:3 abid:7
    v_mfma_f32_4x4x4_16b_bf16 v[20:23], v[40:41], v[94:95], 0 cbsz:3 abid:7
    v_add_u32_dpp v57, v52, v224 row_newbcast:13 row_mask:0xf bank_mask:0xf
    v_exp_f32 v48, v136
    buffer_load_dwordx4 v[84:87], v57, s[12:15], 0 offen
    v_exp_f32 v49, v137
    s_bfe_u32 s38, s40, 0x40018
    v_pk_add_f32 v[48:49], v[48:49], 1.0 op_sel_hi:[1,0]
    v_rcp_f32 v48, v48
    v_rcp_f32 v49, v49
    s_set_gpr_idx_on s38, gpr_idx(SRC2,DST)
    v_pk_fma_f32 v[184:185], v[8:9], v[134:135], v[184:185] op_sel:[0,0,0] op_sel_hi:[1,0,1]
    v_pk_fma_f32 v[194:195], v[10:11], v[134:135], v[194:195] op_sel:[0,0,0] op_sel_hi:[1,0,1]
    v_pk_fma_f32 v[204:205], v[12:13], v[150:151], v[204:205] op_sel:[0,0,0] op_sel_hi:[1,0,1]
    v_pk_fma_f32 v[214:215], v[14:15], v[150:151], v[214:215] op_sel:[0,0,0] op_sel_hi:[1,0,1]
    s_set_gpr_idx_off
    v_pk_mul_f32 v[136:137], v[136:137], v[48:49]
    s_setprio 0
    s_waitcnt vmcnt(5)
    v_mfma_f32_4x4x4_16b_bf16 v[8:11], v[42:43], v[64:65], 0 cbsz:3 abid:0
    v_mfma_f32_4x4x4_16b_bf16 v[12:15], v[42:43], v[66:67], 0 cbsz:3 abid:0
    v_add_u32_dpp v56, v52, v224 row_newbcast:14 row_mask:0xf bank_mask:0xf
    v_exp_f32 v48, v152
    buffer_load_dwordx4 v[88:91], v56, s[12:15], 0 offen
    v_exp_f32 v49, v153
    s_bfe_u32 s38, s40, 0x4001c
    v_pk_add_f32 v[48:49], v[48:49], 1.0 op_sel_hi:[1,0]
    v_rcp_f32 v48, v48
    v_rcp_f32 v49, v49
    s_set_gpr_idx_on s38, gpr_idx(SRC2,DST)
    v_pk_fma_f32 v[184:185], v[16:17], v[134:135], v[184:185] op_sel:[0,1,0] op_sel_hi:[1,1,1]
    v_pk_fma_f32 v[194:195], v[18:19], v[134:135], v[194:195] op_sel:[0,1,0] op_sel_hi:[1,1,1]
    v_pk_fma_f32 v[204:205], v[20:21], v[150:151], v[204:205] op_sel:[0,1,0] op_sel_hi:[1,1,1]
    v_pk_fma_f32 v[214:215], v[22:23], v[150:151], v[214:215] op_sel:[0,1,0] op_sel_hi:[1,1,1]
    s_set_gpr_idx_off
    v_pk_mul_f32 v[152:153], v[152:153], v[48:49]
    s_waitcnt lgkmcnt(0)
    v_mfma_f32_4x4x4_16b_bf16 v[24:27], v[50:51], v[176:177], 0
    v_mfma_f32_4x4x4_16b_bf16 v[28:31], v[50:51], v[178:179], 0
    v_mfma_f32_4x4x4_16b_bf16 v[32:35], v[50:51], v[180:181], 0
    v_mfma_f32_4x4x4_16b_bf16 v[36:39], v[50:51], v[182:183], 0
    s_waitcnt vmcnt(5)
    v_mfma_f32_4x4x4_16b_bf16 v[16:19], v[42:43], v[68:69], 0 cbsz:3 abid:1
    v_mfma_f32_4x4x4_16b_bf16 v[20:23], v[42:43], v[70:71], 0 cbsz:3 abid:1
    v_add_u32_dpp v57, v52, v224 row_newbcast:15 row_mask:0xf bank_mask:0xf
    v_exp_f32 v48, v138
    buffer_load_dwordx4 v[92:95], v57, s[12:15], 0 offen
    v_exp_f32 v49, v139
    s_bfe_u32 s38, s41, 0x40000
    v_pk_add_f32 v[48:49], v[48:49], 1.0 op_sel_hi:[1,0]
    v_rcp_f32 v48, v48
    v_rcp_f32 v49, v49
    s_set_gpr_idx_on s38, gpr_idx(SRC2,DST)
    v_pk_fma_f32 v[184:185], v[8:9], v[136:137], v[184:185] op_sel:[0,0,0] op_sel_hi:[1,0,1]
    v_pk_fma_f32 v[194:195], v[10:11], v[136:137], v[194:195] op_sel:[0,0,0] op_sel_hi:[1,0,1]
    v_pk_fma_f32 v[204:205], v[12:13], v[152:153], v[204:205] op_sel:[0,0,0] op_sel_hi:[1,0,1]
    v_pk_fma_f32 v[214:215], v[14:15], v[152:153], v[214:215] op_sel:[0,0,0] op_sel_hi:[1,0,1]
    s_set_gpr_idx_off
    v_pk_mul_f32 v[138:139], v[138:139], v[48:49]
    v_bfe_u32 v58, v54, 17, 3
    s_waitcnt vmcnt(5)
    v_mfma_f32_4x4x4_16b_bf16 v[8:11], v[42:43], v[72:73], 0 cbsz:3 abid:2
    v_mfma_f32_4x4x4_16b_bf16 v[12:15], v[42:43], v[74:75], 0 cbsz:3 abid:2
    v_add_u32_dpp v56, v53, v224 row_newbcast:0 row_mask:0xf bank_mask:0xf
    v_exp_f32 v48, v154
    buffer_load_dwordx4 v[64:67], v56, s[12:15], 0 offen
    v_exp_f32 v49, v155
    s_bfe_u32 s38, s41, 0x40004
    v_pk_add_f32 v[48:49], v[48:49], 1.0 op_sel_hi:[1,0]
    v_rcp_f32 v48, v48
    v_rcp_f32 v49, v49
    s_set_gpr_idx_on s38, gpr_idx(SRC2,DST)
    v_pk_fma_f32 v[184:185], v[16:17], v[136:137], v[184:185] op_sel:[0,1,0] op_sel_hi:[1,1,1]
    v_pk_fma_f32 v[194:195], v[18:19], v[136:137], v[194:195] op_sel:[0,1,0] op_sel_hi:[1,1,1]
    v_pk_fma_f32 v[204:205], v[20:21], v[152:153], v[204:205] op_sel:[0,1,0] op_sel_hi:[1,1,1]
    v_pk_fma_f32 v[214:215], v[22:23], v[152:153], v[214:215] op_sel:[0,1,0] op_sel_hi:[1,1,1]
    s_set_gpr_idx_off
    v_pk_mul_f32 v[154:155], v[154:155], v[48:49]
    v_lshlrev_b32 v58, v229, v58
    v_cvt_pk_bf16_f32 v40, v24, v28
    v_cvt_pk_bf16_f32 v41, v32, v36
    s_waitcnt vmcnt(5)
    v_mfma_f32_4x4x4_16b_bf16 v[16:19], v[42:43], v[76:77], 0 cbsz:3 abid:3
    v_mfma_f32_4x4x4_16b_bf16 v[20:23], v[42:43], v[78:79], 0 cbsz:3 abid:3
    v_add_u32_dpp v57, v53, v224 row_newbcast:1 row_mask:0xf bank_mask:0xf
    v_exp_f32 v48, v140
    buffer_load_dwordx4 v[68:71], v57, s[12:15], 0 offen
    v_exp_f32 v49, v141
    s_bfe_u32 s38, s41, 0x40008
    v_pk_add_f32 v[48:49], v[48:49], 1.0 op_sel_hi:[1,0]
    v_rcp_f32 v48, v48
    v_rcp_f32 v49, v49
    s_set_gpr_idx_on s38, gpr_idx(SRC2,DST)
    v_pk_fma_f32 v[184:185], v[8:9], v[138:139], v[184:185] op_sel:[0,0,0] op_sel_hi:[1,0,1]
    v_pk_fma_f32 v[194:195], v[10:11], v[138:139], v[194:195] op_sel:[0,0,0] op_sel_hi:[1,0,1]
    v_pk_fma_f32 v[204:205], v[12:13], v[154:155], v[204:205] op_sel:[0,0,0] op_sel_hi:[1,0,1]
    v_pk_fma_f32 v[214:215], v[14:15], v[154:155], v[214:215] op_sel:[0,0,0] op_sel_hi:[1,0,1]
    s_set_gpr_idx_off
    v_pk_mul_f32 v[140:141], v[140:141], v[48:49]
    v_or_b32_dpp v58, v58, v58 row_shr:1 row_mask:0xf bank_mask:0xf bound_ctrl:0
    s_waitcnt vmcnt(5)
    v_mfma_f32_4x4x4_16b_bf16 v[8:11], v[42:43], v[80:81], 0 cbsz:3 abid:4
    v_mfma_f32_4x4x4_16b_bf16 v[12:15], v[42:43], v[82:83], 0 cbsz:3 abid:4
    v_add_u32_dpp v56, v53, v224 row_newbcast:2 row_mask:0xf bank_mask:0xf
    v_exp_f32 v48, v156
    buffer_load_dwordx4 v[72:75], v56, s[12:15], 0 offen
    v_exp_f32 v49, v157
    s_bfe_u32 s38, s41, 0x4000c
    v_pk_add_f32 v[48:49], v[48:49], 1.0 op_sel_hi:[1,0]
    v_rcp_f32 v48, v48
    v_rcp_f32 v49, v49
    s_set_gpr_idx_on s38, gpr_idx(SRC2,DST)
    v_pk_fma_f32 v[184:185], v[16:17], v[138:139], v[184:185] op_sel:[0,1,0] op_sel_hi:[1,1,1]
    v_pk_fma_f32 v[194:195], v[18:19], v[138:139], v[194:195] op_sel:[0,1,0] op_sel_hi:[1,1,1]
    v_pk_fma_f32 v[204:205], v[20:21], v[154:155], v[204:205] op_sel:[0,1,0] op_sel_hi:[1,1,1]
    v_pk_fma_f32 v[214:215], v[22:23], v[154:155], v[214:215] op_sel:[0,1,0] op_sel_hi:[1,1,1]
    s_set_gpr_idx_off
    v_pk_mul_f32 v[156:157], v[156:157], v[48:49]
    v_or_b32_dpp v58, v58, v58 row_shr:2 row_mask:0xf bank_mask:0xf bound_ctrl:0
    s_waitcnt vmcnt(5)
    v_mfma_f32_4x4x4_16b_bf16 v[16:19], v[42:43], v[84:85], 0 cbsz:3 abid:5
    v_mfma_f32_4x4x4_16b_bf16 v[20:23], v[42:43], v[86:87], 0 cbsz:3 abid:5
    v_add_u32_dpp v57, v53, v224 row_newbcast:3 row_mask:0xf bank_mask:0xf
    v_exp_f32 v48, v142
    buffer_load_dwordx4 v[76:79], v57, s[12:15], 0 offen
    v_exp_f32 v49, v143
    s_bfe_u32 s38, s41, 0x40010
    v_pk_add_f32 v[48:49], v[48:49], 1.0 op_sel_hi:[1,0]
    v_rcp_f32 v48, v48
    v_rcp_f32 v49, v49
    s_set_gpr_idx_on s38, gpr_idx(SRC2,DST)
    v_pk_fma_f32 v[184:185], v[8:9], v[140:141], v[184:185] op_sel:[0,0,0] op_sel_hi:[1,0,1]
    v_pk_fma_f32 v[194:195], v[10:11], v[140:141], v[194:195] op_sel:[0,0,0] op_sel_hi:[1,0,1]
    v_pk_fma_f32 v[204:205], v[12:13], v[156:157], v[204:205] op_sel:[0,0,0] op_sel_hi:[1,0,1]
    v_pk_fma_f32 v[214:215], v[14:15], v[156:157], v[214:215] op_sel:[0,0,0] op_sel_hi:[1,0,1]
    s_set_gpr_idx_off
    v_pk_mul_f32 v[142:143], v[142:143], v[48:49]
    v_or_b32_dpp v58, v58, v58 row_shr:4 row_mask:0xf bank_mask:0xf bound_ctrl:0
    s_waitcnt vmcnt(5)
    v_mfma_f32_4x4x4_16b_bf16 v[8:11], v[42:43], v[88:89], 0 cbsz:3 abid:6
    v_mfma_f32_4x4x4_16b_bf16 v[12:15], v[42:43], v[90:91], 0 cbsz:3 abid:6
    v_add_u32_dpp v56, v53, v224 row_newbcast:4 row_mask:0xf bank_mask:0xf
    v_exp_f32 v48, v158
    buffer_load_dwordx4 v[80:83], v56, s[12:15], 0 offen
    v_exp_f32 v49, v159
    s_bfe_u32 s38, s41, 0x40014
    v_pk_add_f32 v[48:49], v[48:49], 1.0 op_sel_hi:[1,0]
    v_rcp_f32 v48, v48
    v_rcp_f32 v49, v49
    s_set_gpr_idx_on s38, gpr_idx(SRC2,DST)
    v_pk_fma_f32 v[184:185], v[16:17], v[140:141], v[184:185] op_sel:[0,1,0] op_sel_hi:[1,1,1]
    v_pk_fma_f32 v[194:195], v[18:19], v[140:141], v[194:195] op_sel:[0,1,0] op_sel_hi:[1,1,1]
    v_pk_fma_f32 v[204:205], v[20:21], v[156:157], v[204:205] op_sel:[0,1,0] op_sel_hi:[1,1,1]
    v_pk_fma_f32 v[214:215], v[22:23], v[156:157], v[214:215] op_sel:[0,1,0] op_sel_hi:[1,1,1]
    s_set_gpr_idx_off
    v_pk_mul_f32 v[158:159], v[158:159], v[48:49]
    s_waitcnt vmcnt(5)
    v_mfma_f32_4x4x4_16b_bf16 v[16:19], v[42:43], v[92:93], 0 cbsz:3 abid:7
    v_mfma_f32_4x4x4_16b_bf16 v[20:23], v[42:43], v[94:95], 0 cbsz:3 abid:7
    v_add_u32_dpp v57, v53, v224 row_newbcast:5 row_mask:0xf bank_mask:0xf
    buffer_load_dwordx4 v[84:87], v57, s[12:15], 0 offen
    s_bfe_u32 s38, s41, 0x40018
    s_set_gpr_idx_on s38, gpr_idx(SRC2,DST)
    v_pk_fma_f32 v[184:185], v[8:9], v[142:143], v[184:185] op_sel:[0,0,0] op_sel_hi:[1,0,1]
    v_pk_fma_f32 v[194:195], v[10:11], v[142:143], v[194:195] op_sel:[0,0,0] op_sel_hi:[1,0,1]
    v_pk_fma_f32 v[204:205], v[12:13], v[158:159], v[204:205] op_sel:[0,0,0] op_sel_hi:[1,0,1]
    v_pk_fma_f32 v[214:215], v[14:15], v[158:159], v[214:215] op_sel:[0,0,0] op_sel_hi:[1,0,1]
    s_set_gpr_idx_off
    v_cvt_pk_bf16_f32 v42, v25, v29
    v_cvt_pk_bf16_f32 v43, v33, v37
    s_bfe_u32 s38, s41, 0x4001c
    v_mov_b32 v52, v53
    v_and_b32 v53, 0x3fff, v54
    v_lshlrev_b32 v53, 9, v53
    s_set_gpr_idx_on s38, gpr_idx(SRC2,DST)
    v_pk_fma_f32 v[184:185], v[16:17], v[142:143], v[184:185] op_sel:[0,1,0] op_sel_hi:[1,1,1]
    v_pk_fma_f32 v[194:195], v[18:19], v[142:143], v[194:195] op_sel:[0,1,0] op_sel_hi:[1,1,1]
    v_pk_fma_f32 v[204:205], v[20:21], v[158:159], v[204:205] op_sel:[0,1,0] op_sel_hi:[1,1,1]
    v_pk_fma_f32 v[214:215], v[22:23], v[158:159], v[214:215] op_sel:[0,1,0] op_sel_hi:[1,1,1]
    s_set_gpr_idx_off
    s_mov_b64 s[40:41], s[42:43]
    v_readlane_b32 s42, v58, 7
    v_readlane_b32 s43, v58, 15
    s_add_u32 s36, s36, 32
    v_bfi_b32 v55, 31, v225, v55
    s_cmp_lt_i32 s36, s77
    s_cbranch_scc1 K2_TILEH
    s_branch K2_LAST
K2_Wh:
    s_branch K1_BACK
    s_nop 0
    s_nop 0
    s_nop 0
    s_nop 0
    s_nop 0
    s_nop 0
    s_nop 0
    s_nop 0
    s_nop 0
K2_TILE:
    s_waitcnt vmcnt(16)
    v_mfma_f32_32x32x16_bf16 v[128:143], v[44:47], v[160:163], 0
    v_mfma_f32_32x32x16_bf16 v[128:143], v[44:47], v[164:167], v[128:143]
    v_mfma_f32_32x32x16_bf16 v[144:159], v[44:47], v[168:171], 0
    v_mfma_f32_32x32x16_bf16 v[144:159], v[44:47], v[172:175], v[144:159]
    buffer_load_dwordx4 v[44:47], v55, s[16:19], 0 offen
    ds_read_b32 v55, v60 offset:36620
    v_add_u32 v60, 512, v60
    ds_read_b64 v[50:51], v61 offset:36096
    ds_read_b32 v54, v59 offset:36616
    v_add_u32 v61, 512, v61
    v_add_u32 v59, 512, v59
    s_nop 3
    v_exp_f32 v48, v128
    v_exp_f32 v49, v129
    s_nop 0
    v_pk_add_f32 v[48:49], v[48:49], 1.0 op_sel_hi:[1,0]
    v_rcp_f32 v48, v48
    v_rcp_f32 v49, v49
    s_nop 0
    v_pk_mul_f32 v[128:129], v[128:129], v[48:49]
    s_waitcnt vmcnt(6)
    v_mfma_f32_4x4x4_16b_bf16 v[8:11], v[40:41], v[64:65], 0 cbsz:3 abid:0
    v_mfma_f32_4x4x4_16b_bf16 v[12:15], v[40:41], v[66:67], 0 cbsz:3 abid:0
    v_add_u32_dpp v56, v52, v224 row_newbcast:6 row_mask:0xf bank_mask:0xf
    v_exp_f32 v48, v144
    buffer_load_dwordx4 v[88:91], v56, s[12:15], 0 offen
    v_exp_f32 v49, v145
    s_nop 0
    v_pk_add_f32 v[48:49], v[48:49], 1.0 op_sel_hi:[1,0]
    v_rcp_f32 v48, v48
    v_rcp_f32 v49, v49
    s_nop 0
    v_pk_mul_f32 v[144:145], v[144:145], v[48:49]
    s_waitcnt vmcnt(6)
    v_mfma_f32_4x4x4_16b_bf16 v[16:19], v[40:41], v[68:69], 0 cbsz:3 abid:1
    v_mfma_f32_4x4x4_16b_bf16 v[20:23], v[40:41], v[70:71], 0 cbsz:3 abid:1
    v_add_u32_dpp v57, v52, v224 row_newbcast:7 row_mask:0xf bank_mask:0xf
    v_exp_f32 v48, v130
    buffer_load_dwordx4 v[92:95], v57, s[12:15], 0 offen
    v_exp_f32 v49, v131
    s_bfe_u32 s38, s40, 0x40000
    v_pk_add_f32 v[48:49], v[48:49], 1.0 op_sel_hi:[1,0]
    v_rcp_f32 v48, v48
    v_rcp_f32 v49, v49
    s_set_gpr_idx_on s38, gpr_idx(SRC2,DST)
    v_pk_fma_f32 v[184:185], v[8:9], v[128:129], v[184:185] op_sel:[0,0,0] op_sel_hi:[1,0,1]
    v_pk_fma_f32 v[194:195], v[10:11], v[128:129], v[194:195] op_sel:[0,0,0] op_sel_hi:[1,0,1]
    v_pk_fma_f32 v[204:205], v[12:13], v[144:145], v[204:205] op_sel:[0,0,0] op_sel_hi:[1,0,1]
    v_pk_fma_f32 v[214:215], v[14:15], v[144:145], v[214:215] op_sel:[0,0,0] op_sel_hi:[1,0,1]
    s_set_gpr_idx_off
    v_pk_mul_f32 v[130:131], v[130:131], v[48:49]
    s_waitcnt vmcnt(6)
    v_mfma_f32_4x4x4_16b_bf16 v[8:11], v[40:41], v[72:73], 0 cbsz:3 abid:2
    v_mfma_f32_4x4x4_16b_bf16 v[12:15], v[40:41], v[74:75], 0 cbsz:3 abid:2
    v_add_u32_dpp v56, v52, v224 row_newbcast:8 row_mask:0xf bank_mask:0xf
    v_exp_f32 v48, v146
    buffer_load_dwordx4 v[64:67], v56, s[12:15], 0 offen
    v_exp_f32 v49, v147
    s_bfe_u32 s38, s40, 0x40004
    v_pk_add_f32 v[48:49], v[48:49], 1.0 op_sel_hi:[1,0]
    v_rcp_f32 v48, v48
    v_rcp_f32 v49, v49
    s_set_gpr_idx_on s38, gpr_idx(SRC2,DST)
    v_pk_fma_f32 v[184:185], v[16:17], v[128:129], v[184:185] op_sel:[0,1,0] op_sel_hi:[1,1,1]
    v_pk_fma_f32 v[194:195], v[18:19], v[128:129], v[194:195] op_sel:[0,1,0] op_sel_hi:[1,1,1]
    v_pk_fma_f32 v[204:205], v[20:21], v[144:145], v[204:205] op_sel:[0,1,0] op_sel_hi:[1,1,1]
    v_pk_fma_f32 v[214:215], v[22:23], v[144:145], v[214:215] op_sel:[0,1,0] op_sel_hi:[1,1,1]
    s_set_gpr_idx_off
    v_pk_mul_f32 v[146:147], v[146:147], v[48:49]
    s_waitcnt vmcnt(6)
    v_mfma_f32_4x4x4_16b_bf16 v[16:19], v[40:41], v[76:77], 0 cbsz:3 abid:3
    v_mfma_f32_4x4x4_16b_bf16 v[20:23], v[40:41], v[78:79], 0 cbsz:3 abid:3
    v_add_u32_dpp v57, v52, v224 row_newbcast:9 row_mask:0xf bank_mask:0xf
    v_exp_f32 v48, v132
    buffer_load_dwordx4 v[68:71], v57, s[12:15], 0 offen
    v_exp_f32 v49, v133
    s_bfe_u32 s38, s40, 0x40008
    v_pk_add_f32 v[48:49], v[48:49], 1.0 op_sel_hi:[1,0]
    v_rcp_f32 v48, v48
    v_rcp_f32 v49, v49
    s_set_gpr_idx_on s38, gpr_idx(SRC2,DST)
    v_pk_fma_f32 v[184:185], v[8:9], v[130:131], v[184:185] op_sel:[0,0,0] op_sel_hi:[1,0,1]
    v_pk_fma_f32 v[194:195], v[10:11], v[130:131], v[194:195] op_sel:[0,0,0] op_sel_hi:[1,0,1]
    v_pk_fma_f32 v[204:205], v[12:13], v[146:147], v[204:205] op_sel:[0,0,0] op_sel_hi:[1,0,1]
    v_pk_fma_f32 v[214:215], v[14:15], v[146:147], v[214:215] op_sel:[0,0,0] op_sel_hi:[1,0,1]
    s_set_gpr_idx_off
    v_pk_mul_f32 v[132:133], v[132:133], v[48:49]
    s_waitcnt vmcnt(6)
    v_mfma_f32_4x4x4_16b_bf16 v[8:11], v[40:41], v[80:81], 0 cbsz:3 abid:4
    v_mfma_f32_4x4x4_16b_bf16 v[12:15], v[40:41], v[82:83], 0 cbsz:3 abid:4
    v_add_u32_dpp v56, v52, v224 row_newbcast:10 row_mask:0xf bank_mask:0xf
    v_exp_f32 v48, v148
    buffer_load_dwordx4 v[72:75], v56, s[12:15], 0 offen
    v_exp_f32 v49, v149
    s_bfe_u32 s38, s40, 0x4000c
    v_pk_add_f32 v[48:49], v[48:49], 1.0 op_sel_hi:[1,0]
    v_rcp_f32 v48, v48
    v_rcp_f32 v49, v49
    s_set_gpr_idx_on s38, gpr_idx(SRC2,DST)
    v_pk_fma_f32 v[184:185], v[16:17], v[130:131], v[184:185] op_sel:[0,1,0] op_sel_hi:[1,1,1]
    v_pk_fma_f32 v[194:195], v[18:19], v[130:131], v[194:195] op_sel:[0,1,0] op_sel_hi:[1,1,1]
    v_pk_fma_f32 v[204:205], v[20:21], v[146:147], v[204:205] op_sel:[0,1,0] op_sel_hi:[1,1,1]
    v_pk_fma_f32 v[214:215], v[22:23], v[146:147], v[214:215] op_sel:[0,1,0] op_sel_hi:[1,1,1]
    s_set_gpr_idx_off
    v_pk_mul_f32 v[148:149], v[148:149], v[48:49]
    s_waitcnt vmcnt(6)
    v_mfma_f32_4x4x4_16b_bf16 v[16:19], v[40:41], v[84:85], 0 cbsz:3 abid:5
    v_mfma_f32_4x4x4_16b_bf16 v[20:23], v[40:41], v[86:87], 0 cbsz:3 abid:5
    v_add_u32_dpp v57, v52, v224 row_newbcast:11 row_mask:0xf bank_mask:0xf
    v_exp_f32 v48, v134
    buffer_load_dwordx4 v[76:79], v57, s[12:15], 0 offen
    v_exp_f32 v49, v135
    s_bfe_u32 s38, s40, 0x40010
    v_pk_add_f32 v[48:49], v[48:49], 1.0 op_sel_hi:[1,0]
    v_rcp_f32 v48, v48
    v_rcp_f32 v49, v49
    s_set_gpr_idx_on s38, gpr_idx(SRC2,DST)
    v_pk_fma_f32 v[184:185], v[8:9], v[132:133], v[184:185] op_sel:[0,0,0] op_sel_hi:[1,0,1]
    v_pk_fma_f32 v[194:195], v[10:11], v[132:133], v[194:195] op_sel:[0,0,0] op_sel_hi:[1,0,1]
    v_pk_fma_f32 v[204:205], v[12:13], v[148:149], v[204:205] op_sel:[0,0,0] op_sel_hi:[1,0,1]
    v_pk_fma_f32 v[214:215], v[14:15], v[148:149], v[214:215] op_sel:[0,0,0] op_sel_hi:[1,0,1]
    s_set_gpr_idx_off
    v_pk_mul_f32 v[134:135], v[134:135], v[48:49]
    s_waitcnt vmcnt(5)
    v_mfma_f32_4x4x4_16b_bf16 v[8:11], v[40:41], v[88:89], 0 cbsz:3 abid:6
    v_mfma_f32_4x4x4_16b_bf16 v[12:15], v[40:41], v[90:91], 0 cbsz:3 abid:6
    v_add_u32_dpp v56, v52, v224 row_newbcast:12 row_mask:0xf bank_mask:0xf
    v_exp_f32 v48, v150
    buffer_load_dwordx4 v[80:83], v56, s[12:15], 0 offen
    v_exp_f32 v49, v151
    s_bfe_u32 s38, s40, 0x40014
    v_pk_add_f32 v[48:49], v[48:49], 1.0 op_sel_hi:[1,0]
    v_rcp_f32 v48, v48
    v_rcp_f32 v49, v49
    s_set_gpr_idx_on s38, gpr_idx(SRC2,DST)
    v_pk_fma_f32 v[184:185], v[16:17], v[132:133], v[184:185] op_sel:[0,1,0] op_sel_hi:[1,1,1]
    v_pk_fma_f32 v[194:195], v[18:19], v[132:133], v[194:195] op_sel:[0,1,0] op_sel_hi:[1,1,1]
    v_pk_fma_f32 v[204:205], v[20:21], v[148:149], v[204:205] op_sel:[0,1,0] op_sel_hi:[1,1,1]
    v_pk_fma_f32 v[214:215], v[22:23], v[148:149], v[214:215] op_sel:[0,1,0] op_sel_hi:[1,1,1]
    s_set_gpr_idx_off
    v_pk_mul_f32 v[150:151], v[150:151], v[48:49]
    s_waitcnt vmcnt(5)
    v_mfma_f32_4x4x4_16b_bf16 v[16:19], v[40:41], v[92:93], 0 cbsz:3 abid:7
    v_mfma_f32_4x4x4_16b_bf16 v[20:23], v[40:41], v[94:95], 0 cbsz:3 abid:7
    v_add_u32_dpp v57, v52, v224 row_newbcast:13 row_mask:0xf bank_mask:0xf
    v_exp_f32 v48, v136
    buffer_load_dwordx4 v[84:87], v57, s[12:15], 0 offen
    v_exp_f32 v49, v137
    s_bfe_u32 s38, s40, 0x40018
    v_pk_add_f32 v[48:49], v[48:49], 1.0 op_sel_hi:[1,0]
    v_rcp_f32 v48, v48
    v_rcp_f32 v49, v49
    s_set_gpr_idx_on s38, gpr_idx(SRC2,DST)
    v_pk_fma_f32 v[184:185], v[8:9], v[134:135], v[184:185] op_sel:[0,0,0] op_sel_hi:[1,0,1]
    v_pk_fma_f32 v[194:195], v[10:11], v[134:135], v[194:195] op_sel:[0,0,0] op_sel_hi:[1,0,1]
    v_pk_fma_f32 v[204:205], v[12:13], v[150:151], v[204:205] op_sel:[0,0,0] op_sel_hi:[1,0,1]
    v_pk_fma_f32 v[214:215], v[14:15], v[150:151], v[214:215] op_sel:[0,0,0] op_sel_hi:[1,0,1]
    s_set_gpr_idx_off
    v_pk_mul_f32 v[136:137], v[136:137], v[48:49]
    s_waitcnt vmcnt(5)
    v_mfma_f32_4x4x4_16b_bf16 v[8:11], v[42:43], v[64:65], 0 cbsz:3 abid:0
    v_mfma_f32_4x4x4_16b_bf16 v[12:15], v[42:43], v[66:67], 0 cbsz:3 abid:0
    v_add_u32_dpp v56, v52, v224 row_newbcast:14 row_mask:0xf bank_mask:0xf
    v_exp_f32 v48, v152
    buffer_load_dwordx4 v[88:91], v56, s[12:15], 0 offen
    v_exp_f32 v49, v153
    s_bfe_u32 s38, s40, 0x4001c
    v_pk_add_f32 v[48:49], v[48:49], 1.0 op_sel_hi:[1,0]
    v_rcp_f32 v48, v48
    v_rcp_f32 v49, v49
    s_set_gpr_idx_on s38, gpr_idx(SRC2,DST)
    v_pk_fma_f32 v[184:185], v[16:17], v[134:135], v[184:185] op_sel:[0,1,0] op_sel_hi:[1,1,1]
    v_pk_fma_f32 v[194:195], v[18:19], v[134:135], v[194:195] op_sel:[0,1,0] op_sel_hi:[1,1,1]
    v_pk_fma_f32 v[204:205], v[20:21], v[150:151], v[204:205] op_sel:[0,1,0] op_sel_hi:[1,1,1]
    v_pk_fma_f32 v[214:215], v[22:23], v[150:151], v[214:215] op_sel:[0,1,0] op_sel_hi:[1,1,1]
    s_set_gpr_idx_off
    v_pk_mul_f32 v[152:153], v[152:153], v[48:49]
    s_waitcnt lgkmcnt(0)
    v_mfma_f32_4x4x4_16b_bf16 v[24:27], v[50:51], v[176:177], 0
    v_mfma_f32_4x4x4_16b_bf16 v[28:31], v[50:51], v[178:179], 0
    v_mfma_f32_4x4x4_16b_bf16 v[32:35], v[50:51], v[180:181], 0
    v_mfma_f32_4x4x4_16b_bf16 v[36:39], v[50:51], v[182:183], 0
    s_waitcnt vmcnt(5)
    v_mfma_f32_4x4x4_16b_bf16 v[16:19], v[42:43], v[68:69], 0 cbsz:3 abid:1
    v_mfma_f32_4x4x4_16b_bf16 v[20:23], v[42:43], v[70:71], 0 cbsz:3 abid:1
    v_add_u32_dpp v57, v52, v224 row_newbcast:15 row_mask:0xf bank_mask:0xf
    v_exp_f32 v48, v138
    buffer_load_dwordx4 v[92:95], v57, s[12:15], 0 offen
    v_exp_f32 v49, v139
    s_bfe_u32 s38, s41, 0x40000
    v_pk_add_f32 v[48:49], v[48:49], 1.0 op_sel_hi:[1,0]
    v_rcp_f32 v48, v48
    v_rcp_f32 v49, v49
    s_set_gpr_idx_on s38, gpr_idx(SRC2,DST)
    v_pk_fma_f32 v[184:185], v[8:9], v[136:137], v[184:185] op_sel:[0,0,0] op_sel_hi:[1,0,1]
    v_pk_fma_f32 v[194:195], v[10:11], v[136:137], v[194:195] op_sel:[0,0,0] op_sel_hi:[1,0,1]
    v_pk_fma_f32 v[204:205], v[12:13], v[152:153], v[204:205] op_sel:[0,0,0] op_sel_hi:[1,0,1]
    v_pk_fma_f32 v[214:215], v[14:15], v[152:153], v[214:215] op_sel:[0,0,0] op_sel_hi:[1,0,1]
    s_set_gpr_idx_off
    v_pk_mul_f32 v[138:139], v[138:139], v[48:49]
    v_bfe_u32 v58, v54, 17, 3
    s_waitcnt vmcnt(5)
    v_mfma_f32_4x4x4_16b_bf16 v[8:11], v[42:43], v[72:73], 0 cbsz:3 abid:2
    v_mfma_f32_4x4x4_16b_bf16 v[12:15], v[42:43], v[74:75], 0 cbsz:3 abid:2
    v_add_u32_dpp v56, v53, v224 row_newbcast:0 row_mask:0xf bank_mask:0xf
    v_exp_f32 v48, v154
    buffer_load_dwordx4 v[64:67], v56, s[12:15], 0 offen
    v_exp_f32 v49, v155
    s_bfe_u32 s38, s41, 0x40004
    v_pk_add_f32 v[48:49], v[48:49], 1.0 op_sel_hi:[1,0]
    v_rcp_f32 v48, v48
    v_rcp_f32 v49, v49
    s_set_gpr_idx_on s38, gpr_idx(SRC2,DST)
    v_pk_fma_f32 v[184:185], v[16:17], v[136:137], v[184:185] op_sel:[0,1,0] op_sel_hi:[1,1,1]
    v_pk_fma_f32 v[194:195], v[18:19], v[136:137], v[194:195] op_sel:[0,1,0] op_sel_hi:[1,1,1]
    v_pk_fma_f32 v[204:205], v[20:21], v[152:153], v[204:205] op_sel:[0,1,0] op_sel_hi:[1,1,1]
    v_pk_fma_f32 v[214:215], v[22:23], v[152:153], v[214:215] op_sel:[0,1,0] op_sel_hi:[1,1,1]
    s_set_gpr_idx_off
    v_pk_mul_f32 v[154:155], v[154:155], v[48:49]
    v_lshlrev_b32 v58, v229, v58
    v_cvt_pk_bf16_f32 v40, v24, v28
    v_cvt_pk_bf16_f32 v41, v32, v36
    s_waitcnt vmcnt(5)
    v_mfma_f32_4x4x4_16b_bf16 v[16:19], v[42:43], v[76:77], 0 cbsz:3 abid:3
    v_mfma_f32_4x4x4_16b_bf16 v[20:23], v[42:43], v[78:79], 0 cbsz:3 abid:3
    v_add_u32_dpp v57, v53, v224 row_newbcast:1 row_mask:0xf bank_mask:0xf
    v_exp_f32 v48, v140
    buffer_load_dwordx4 v[68:71], v57, s[12:15], 0 offen
    v_exp_f32 v49, v141
    s_bfe_u32 s38, s41, 0x40008
    v_pk_add_f32 v[48:49], v[48:49], 1.0 op_sel_hi:[1,0]
    v_rcp_f32 v48, v48
    v_rcp_f32 v49, v49
    s_set_gpr_idx_on s38, gpr_idx(SRC2,DST)
    v_pk_fma_f32 v[184:185], v[8:9], v[138:139], v[184:185] op_sel:[0,0,0] op_sel_hi:[1,0,1]
    v_pk_fma_f32 v[194:195], v[10:11], v[138:139], v[194:195] op_sel:[0,0,0] op_sel_hi:[1,0,1]
    v_pk_fma_f32 v[204:205], v[12:13], v[154:155], v[204:205] op_sel:[0,0,0] op_sel_hi:[1,0,1]
    v_pk_fma_f32 v[214:215], v[14:15], v[154:155], v[214:215] op_sel:[0,0,0] op_sel_hi:[1,0,1]
    s_set_gpr_idx_off
    v_pk_mul_f32 v[140:141], v[140:141], v[48:49]
    v_or_b32_dpp v58, v58, v58 row_shr:1 row_mask:0xf bank_mask:0xf bound_ctrl:0
    s_waitcnt vmcnt(5)
    v_mfma_f32_4x4x4_16b_bf16 v[8:11], v[42:43], v[80:81], 0 cbsz:3 abid:4
    v_mfma_f32_4x4x4_16b_bf16 v[12:15], v[42:43], v[82:83], 0 cbsz:3 abid:4
    v_add_u32_dpp v56, v53, v224 row_newbcast:2 row_mask:0xf bank_mask:0xf
    v_exp_f32 v48, v156
    buffer_load_dwordx4 v[72:75], v56, s[12:15], 0 offen
    v_exp_f32 v49, v157
    s_bfe_u32 s38, s41, 0x4000c
    v_pk_add_f32 v[48:49], v[48:49], 1.0 op_sel_hi:[1,0]
    v_rcp_f32 v48, v48
    v_rcp_f32 v49, v49
    s_set_gpr_idx_on s38, gpr_idx(SRC2,DST)
    v_pk_fma_f32 v[184:185], v[16:17], v[138:139], v[184:185] op_sel:[0,1,0] op_sel_hi:[1,1,1]
    v_pk_fma_f32 v[194:195], v[18:19], v[138:139], v[194:195] op_sel:[0,1,0] op_sel_hi:[1,1,1]
    v_pk_fma_f32 v[204:205], v[20:21], v[154:155], v[204:205] op_sel:[0,1,0] op_sel_hi:[1,1,1]
    v_pk_fma_f32 v[214:215], v[22:23], v[154:155], v[214:215] op_sel:[0,1,0] op_sel_hi:[1,1,1]
    s_set_gpr_idx_off
    v_pk_mul_f32 v[156:157], v[156:157], v[48:49]
    v_or_b32_dpp v58, v58, v58 row_shr:2 row_mask:0xf bank_mask:0xf bound_ctrl:0
    s_waitcnt vmcnt(5)
    v_mfma_f32_4x4x4_16b_bf16 v[16:19], v[42:43], v[84:85], 0 cbsz:3 abid:5
    v_mfma_f32_4x4x4_16b_bf16 v[20:23], v[42:43], v[86:87], 0 cbsz:3 abid:5
    v_add_u32_dpp v57, v53, v224 row_newbcast:3 row_mask:0xf bank_mask:0xf
    v_exp_f32 v48, v142
    buffer_load_dwordx4 v[76:79], v57, s[12:15], 0 offen
    v_exp_f32 v49, v143
    s_bfe_u32 s38, s41, 0x40010
    v_pk_add_f32 v[48:49], v[48:49], 1.0 op_sel_hi:[1,0]
    v_rcp_f32 v48, v48
    v_rcp_f32 v49, v49
    s_set_gpr_idx_on s38, gpr_idx(SRC2,DST)
    v_pk_fma_f32 v[184:185], v[8:9], v[140:141], v[184:185] op_sel:[0,0,0] op_sel_hi:[1,0,1]
    v_pk_fma_f32 v[194:195], v[10:11], v[140:141], v[194:195] op_sel:[0,0,0] op_sel_hi:[1,0,1]
    v_pk_fma_f32 v[204:205], v[12:13], v[156:157], v[204:205] op_sel:[0,0,0] op_sel_hi:[1,0,1]
    v_pk_fma_f32 v[214:215], v[14:15], v[156:157], v[214:215] op_sel:[0,0,0] op_sel_hi:[1,0,1]
    s_set_gpr_idx_off
    v_pk_mul_f32 v[142:143], v[142:143], v[48:49]
    v_or_b32_dpp v58, v58, v58 row_shr:4 row_mask:0xf bank_mask:0xf bound_ctrl:0
    s_waitcnt vmcnt(5)
    v_mfma_f32_4x4x4_16b_bf16 v[8:11], v[42:43], v[88:89], 0 cbsz:3 abid:6
    v_mfma_f32_4x4x4_16b_bf16 v[12:15], v[42:43], v[90:91], 0 cbsz:3 abid:6
    v_add_u32_dpp v56, v53, v224 row_newbcast:4 row_mask:0xf bank_mask:0xf
    v_exp_f32 v48, v158
    buffer_load_dwordx4 v[80:83], v56, s[12:15], 0 offen
    v_exp_f32 v49, v159
    s_bfe_u32 s38, s41, 0x40014
    v_pk_add_f32 v[48:49], v[48:49], 1.0 op_sel_hi:[1,0]
    v_rcp_f32 v48, v48
    v_rcp_f32 v49, v49
    s_set_gpr_idx_on s38, gpr_idx(SRC2,DST)
    v_pk_fma_f32 v[184:185], v[16:17], v[140:141], v[184:185] op_sel:[0,1,0] op_sel_hi:[1,1,1]
    v_pk_fma_f32 v[194:195], v[18:19], v[140:141], v[194:195] op_sel:[0,1,0] op_sel_hi:[1,1,1]
    v_pk_fma_f32 v[204:205], v[20:21], v[156:157], v[204:205] op_sel:[0,1,0] op_sel_hi:[1,1,1]
    v_pk_fma_f32 v[214:215], v[22:23], v[156:157], v[214:215] op_sel:[0,1,0] op_sel_hi:[1,1,1]
    s_set_gpr_idx_off
    v_pk_mul_f32 v[158:159], v[158:159], v[48:49]
    s_waitcnt vmcnt(5)
    v_mfma_f32_4x4x4_16b_bf16 v[16:19], v[42:43], v[92:93], 0 cbsz:3 abid:7
    v_mfma_f32_4x4x4_16b_bf16 v[20:23], v[42:43], v[94:95], 0 cbsz:3 abid:7
    v_add_u32_dpp v57, v53, v224 row_newbcast:5 row_mask:0xf bank_mask:0xf
    buffer_load_dwordx4 v[84:87], v57, s[12:15], 0 offen
    s_bfe_u32 s38, s41, 0x40018
    s_set_gpr_idx_on s38, gpr_idx(SRC2,DST)
    v_pk_fma_f32 v[184:185], v[8:9], v[142:143], v[184:185] op_sel:[0,0,0] op_sel_hi:[1,0,1]
    v_pk_fma_f32 v[194:195], v[10:11], v[142:143], v[194:195] op_sel:[0,0,0] op_sel_hi:[1,0,1]
    v_pk_fma_f32 v[204:205], v[12:13], v[158:159], v[204:205] op_sel:[0,0,0] op_sel_hi:[1,0,1]
    v_pk_fma_f32 v[214:215], v[14:15], v[158:159], v[214:215] op_sel:[0,0,0] op_sel_hi:[1,0,1]
    s_set_gpr_idx_off
    v_cvt_pk_bf16_f32 v42, v25, v29
    v_cvt_pk_bf16_f32 v43, v33, v37
    s_bfe_u32 s38, s41, 0x4001c
    v_mov_b32 v52, v53
    v_and_b32 v53, 0x3fff, v54
    v_lshlrev_b32 v53, 9, v53
    s_set_gpr_idx_on s38, gpr_idx(SRC2,DST)
    v_pk_fma_f32 v[184:185], v[16:17], v[142:143], v[184:185] op_sel:[0,1,0] op_sel_hi:[1,1,1]
    v_pk_fma_f32 v[194:195], v[18:19], v[142:143], v[194:195] op_sel:[0,1,0] op_sel_hi:[1,1,1]
    v_pk_fma_f32 v[204:205], v[20:21], v[158:159], v[204:205] op_sel:[0,1,0] op_sel_hi:[1,1,1]
    v_pk_fma_f32 v[214:215], v[22:23], v[158:159], v[214:215] op_sel:[0,1,0] op_sel_hi:[1,1,1]
    s_set_gpr_idx_off
    s_mov_b64 s[40:41], s[42:43]
    v_readlane_b32 s42, v58, 7
    v_readlane_b32 s43, v58, 15
    s_add_u32 s36, s36, 32
    v_bfi_b32 v55, 31, v225, v55
    s_cmp_lt_i32 s36, s77
    s_cbranch_scc1 K2_TILE
K2_LAST:
    s_cbranch_vccz K2_PLA
    s_setprio 2
K2_PLA:
    s_sub_u32 s39, s37, s36
    s_lshr_b32 s39, s39, 1
    s_nop 0
    s_nop 0
    s_nop 0
    s_nop 0
    s_waitcnt vmcnt(16)
    v_mfma_f32_32x32x16_bf16 v[128:143], v[44:47], v[160:163], 0
    v_mfma_f32_32x32x16_bf16 v[128:143], v[44:47], v[164:167], v[128:143]
    v_mfma_f32_32x32x16_bf16 v[144:159], v[44:47], v[168:171], 0
    v_mfma_f32_32x32x16_bf16 v[144:159], v[44:47], v[172:175], v[144:159]
    v_lshlrev_b32 v240, 4, v1
    s_mul_i32 s76, s28, 2880
    s_add_u32 s76, s76, 12544
    v_lshrrev_b32 v241, 2, v224
    v_mad_u32_u24 v241, v225, 18, v241
    v_add_u32 v241, s76, v241
    v_mad_u32_u24 v242, v224, 9, v225
    v_add_u32 v242, s76, v242
    ds_read_b128 v[96:99], v240 offset:4352
    ds_read_b128 v[100:103], v240 offset:5376
    ds_read_b128 v[104:107], v240 offset:6400
    ds_read_b128 v[108:111], v240 offset:7424
    ds_read_b128 v[112:115], v240 offset:8448
    ds_read_b128 v[116:119], v240 offset:9472
    ds_read_b128 v[120:123], v240 offset:10496
    ds_read_b128 v[124:127], v240 offset:11520
    v_lshrrev_b32 v243, 1, v225
    v_add_u32 v243, s28, v243
    v_add_u32 v244, s30, v243
    v_lshl_add_u32 v244, v244, 9, v224
    v_add_u32 v245, 0, v243
    v_cmp_gt_u32 s[56:57], s31, v245
    v_add_u32 v245, 16, v243
    v_cmp_gt_u32 s[58:59], s31, v245
    v_add_u32 v245, 32, v243
    v_cmp_gt_u32 s[60:61], s31, v245
    v_exp_f32 v48, v128
    v_exp_f32 v49, v129
    s_nop 0
    v_pk_add_f32 v[48:49], v[48:49], 1.0 op_sel_hi:[1,0]
    v_rcp_f32 v48, v48
    v_rcp_f32 v49, v49
    s_nop 0
    v_pk_mul_f32 v[128:129], v[128:129], v[48:49]
    s_waitcnt vmcnt(5)
    v_mfma_f32_4x4x4_16b_bf16 v[8:11], v[40:41], v[64:65], 0 cbsz:3 abid:0
    v_mfma_f32_4x4x4_16b_bf16 v[12:15], v[40:41], v[66:67], 0 cbsz:3 abid:0
    v_add_u32_dpp v56, v52, v224 row_newbcast:6 row_mask:0xf bank_mask:0xf
    v_exp_f32 v48, v144
    buffer_load_dwordx4 v[88:91], v56, s[12:15], 0 offen
    v_exp_f32 v49, v145
    s_nop 0
    v_pk_add_f32 v[48:49], v[48:49], 1.0 op_sel_hi:[1,0]
    v_rcp_f32 v48, v48
    v_rcp_f32 v49, v49
    s_nop 0
    v_pk_mul_f32 v[144:145], v[144:145], v[48:49]
    s_waitcnt vmcnt(5)
    v_mfma_f32_4x4x4_16b_bf16 v[16:19], v[40:41], v[68:69], 0 cbsz:3 abid:1
    v_mfma_f32_4x4x4_16b_bf16 v[20:23], v[40:41], v[70:71], 0 cbsz:3 abid:1
    v_add_u32_dpp v57, v52, v224 row_newbcast:7 row_mask:0xf bank_mask:0xf
    v_exp_f32 v48, v130
    buffer_load_dwordx4 v[92:95], v57, s[12:15], 0 offen
    v_exp_f32 v49, v131
    s_bfe_u32 s38, s40, 0x40000
    v_pk_add_f32 v[48:49], v[48:49], 1.0 op_sel_hi:[1,0]
    v_rcp_f32 v48, v48
    v_rcp_f32 v49, v49
    s_set_gpr_idx_on s38, gpr_idx(SRC2,DST)
    v_pk_fma_f32 v[184:185], v[8:9], v[128:129], v[184:185] op_sel:[0,0,0] op_sel_hi:[1,0,1]
    v_pk_fma_f32 v[194:195], v[10:11], v[128:129], v[194:195] op_sel:[0,0,0] op_sel_hi:[1,0,1]
    v_pk_fma_f32 v[204:205], v[12:13], v[144:145], v[204:205] op_sel:[0,0,0] op_sel_hi:[1,0,1]
    v_pk_fma_f32 v[214:215], v[14:15], v[144:145], v[214:215] op_sel:[0,0,0] op_sel_hi:[1,0,1]
    s_set_gpr_idx_off
    v_pk_mul_f32 v[130:131], v[130:131], v[48:49]
    s_cmp_le_u32 s39, 2
    s_cbranch_scc1 K2_X_2
    s_nop 0
    s_waitcnt vmcnt(5)
    v_mfma_f32_4x4x4_16b_bf16 v[8:11], v[40:41], v[72:73], 0 cbsz:3 abid:2
    v_mfma_f32_4x4x4_16b_bf16 v[12:15], v[40:41], v[74:75], 0 cbsz:3 abid:2
    v_add_u32_dpp v56, v52, v224 row_newbcast:8 row_mask:0xf bank_mask:0xf
    v_exp_f32 v48, v146
    buffer_load_dwordx4 v[64:67], v56, s[12:15], 0 offen
    v_exp_f32 v49, v147
    s_bfe_u32 s38, s40, 0x40004
    v_pk_add_f32 v[48:49], v[48:49], 1.0 op_sel_hi:[1,0]
    v_rcp_f32 v48, v48
    v_rcp_f32 v49, v49
    s_set_gpr_idx_on s38, gpr_idx(SRC2,DST)
    v_pk_fma_f32 v[184:185], v[16:17], v[128:129], v[184:185] op_sel:[0,1,0] op_sel_hi:[1,1,1]
    v_pk_fma_f32 v[194:195], v[18:19], v[128:129], v[194:195] op_sel:[0,1,0] op_sel_hi:[1,1,1]
    v_pk_fma_f32 v[204:205], v[20:21], v[144:145], v[204:205] op_sel:[0,1,0] op_sel_hi:[1,1,1]
    v_pk_fma_f32 v[214:215], v[22:23], v[144:145], v[214:215] op_sel:[0,1,0] op_sel_hi:[1,1,1]
    s_set_gpr_idx_off
    v_pk_mul_f32 v[146:147], v[146:147], v[48:49]
    s_waitcnt vmcnt(5)
    v_mfma_f32_4x4x4_16b_bf16 v[16:19], v[40:41], v[76:77], 0 cbsz:3 abid:3
    v_mfma_f32_4x4x4_16b_bf16 v[20:23], v[40:41], v[78:79], 0 cbsz:3 abid:3
    v_add_u32_dpp v57, v52, v224 row_newbcast:9 row_mask:0xf bank_mask:0xf
    v_exp_f32 v48, v132
    buffer_load_dwordx4 v[68:71], v57, s[12:15], 0 offen
    v_exp_f32 v49, v133
    s_bfe_u32 s38, s40, 0x40008
    v_pk_add_f32 v[48:49], v[48:49], 1.0 op_sel_hi:[1,0]
    v_rcp_f32 v48, v48
    v_rcp_f32 v49, v49
    s_set_gpr_idx_on s38, gpr_idx(SRC2,DST)
    v_pk_fma_f32 v[184:185], v[8:9], v[130:131], v[184:185] op_sel:[0,0,0] op_sel_hi:[1,0,1]
    v_pk_fma_f32 v[194:195], v[10:11], v[130:131], v[194:195] op_sel:[0,0,0] op_sel_hi:[1,0,1]
    v_pk_fma_f32 v[204:205], v[12:13], v[146:147], v[204:205] op_sel:[0,0,0] op_sel_hi:[1,0,1]
    v_pk_fma_f32 v[214:215], v[14:15], v[146:147], v[214:215] op_sel:[0,0,0] op_sel_hi:[1,0,1]
    s_set_gpr_idx_off
    v_pk_mul_f32 v[132:133], v[132:133], v[48:49]
    s_cmp_le_u32 s39, 4
    s_cbranch_scc1 K2_X_4
    s_waitcnt vmcnt(5)
    v_mfma_f32_4x4x4_16b_bf16 v[8:11], v[40:41], v[80:81], 0 cbsz:3 abid:4
    v_mfma_f32_4x4x4_16b_bf16 v[12:15], v[40:41], v[82:83], 0 cbsz:3 abid:4
    v_add_u32_dpp v56, v52, v224 row_newbcast:10 row_mask:0xf bank_mask:0xf
    v_exp_f32 v48, v148
    buffer_load_dwordx4 v[72:75], v56, s[12:15], 0 offen
    v_exp_f32 v49, v149
    s_bfe_u32 s38, s40, 0x4000c
    v_pk_add_f32 v[48:49], v[48:49], 1.0 op_sel_hi:[1,0]
    v_rcp_f32 v48, v48
    v_rcp_f32 v49, v49
    s_set_gpr_idx_on s38, gpr_idx(SRC2,DST)
    v_pk_fma_f32 v[184:185], v[16:17], v[130:131], v[184:185] op_sel:[0,1,0] op_sel_hi:[1,1,1]
    v_pk_fma_f32 v[194:195], v[18:19], v[130:131], v[194:195] op_sel:[0,1,0] op_sel_hi:[1,1,1]
    v_pk_fma_f32 v[204:205], v[20:21], v[146:147], v[204:205] op_sel:[0,1,0] op_sel_hi:[1,1,1]
    v_pk_fma_f32 v[214:215], v[22:23], v[146:147], v[214:215] op_sel:[0,1,0] op_sel_hi:[1,1,1]
    s_set_gpr_idx_off
    v_pk_mul_f32 v[148:149], v[148:149], v[48:49]
    s_waitcnt vmcnt(5)
    v_mfma_f32_4x4x4_16b_bf16 v[16:19], v[40:41], v[84:85], 0 cbsz:3 abid:5
    v_mfma_f32_4x4x4_16b_bf16 v[20:23], v[40:41], v[86:87], 0 cbsz:3 abid:5
    v_add_u32_dpp v57, v52, v224 row_newbcast:11 row_mask:0xf bank_mask:0xf
    v_exp_f32 v48, v134
    buffer_load_dwordx4 v[76:79], v57, s[12:15], 0 offen
    v_exp_f32 v49, v135
    s_bfe_u32 s38, s40, 0x40010
    v_pk_add_f32 v[48:49], v[48:49], 1.0 op_sel_hi:[1,0]
    v_rcp_f32 v48, v48
    v_rcp_f32 v49, v49
    s_set_gpr_idx_on s38, gpr_idx(SRC2,DST)
    v_pk_fma_f32 v[184:185], v[8:9], v[132:133], v[184:185] op_sel:[0,0,0] op_sel_hi:[1,0,1]
    v_pk_fma_f32 v[194:195], v[10:11], v[132:133], v[194:195] op_sel:[0,0,0] op_sel_hi:[1,0,1]
    v_pk_fma_f32 v[204:205], v[12:13], v[148:149], v[204:205] op_sel:[0,0,0] op_sel_hi:[1,0,1]
    v_pk_fma_f32 v[214:215], v[14:15], v[148:149], v[214:215] op_sel:[0,0,0] op_sel_hi:[1,0,1]
    s_set_gpr_idx_off
    v_pk_mul_f32 v[134:135], v[134:135], v[48:49]
    s_cmp_le_u32 s39, 6
    s_cbranch_scc1 K2_X_6
    s_waitcnt vmcnt(5)
    v_mfma_f32_4x4x4_16b_bf16 v[8:11], v[40:41], v[88:89], 0 cbsz:3 abid:6
    v_mfma_f32_4x4x4_16b_bf16 v[12:15], v[40:41], v[90:91], 0 cbsz:3 abid:6
    v_add_u32_dpp v56, v52, v224 row_newbcast:12 row_mask:0xf bank_mask:0xf
    v_exp_f32 v48, v150
    buffer_load_dwordx4 v[80:83], v56, s[12:15], 0 offen
    v_exp_f32 v49, v151
    s_bfe_u32 s38, s40, 0x40014
    v_pk_add_f32 v[48:49], v[48:49], 1.0 op_sel_hi:[1,0]
    v_rcp_f32 v48, v48
    v_rcp_f32 v49, v49
    s_set_gpr_idx_on s38, gpr_idx(SRC2,DST)
    v_pk_fma_f32 v[184:185], v[16:17], v[132:133], v[184:185] op_sel:[0,1,0] op_sel_hi:[1,1,1]
    v_pk_fma_f32 v[194:195], v[18:19], v[132:133], v[194:195] op_sel:[0,1,0] op_sel_hi:[1,1,1]
    v_pk_fma_f32 v[204:205], v[20:21], v[148:149], v[204:205] op_sel:[0,1,0] op_sel_hi:[1,1,1]
    v_pk_fma_f32 v[214:215], v[22:23], v[148:149], v[214:215] op_sel:[0,1,0] op_sel_hi:[1,1,1]
    s_set_gpr_idx_off
    v_pk_mul_f32 v[150:151], v[150:151], v[48:49]
    s_waitcnt vmcnt(5)
    v_mfma_f32_4x4x4_16b_bf16 v[16:19], v[40:41], v[92:93], 0 cbsz:3 abid:7
    v_mfma_f32_4x4x4_16b_bf16 v[20:23], v[40:41], v[94:95], 0 cbsz:3 abid:7
    v_add_u32_dpp v57, v52, v224 row_newbcast:13 row_mask:0xf bank_mask:0xf
    v_exp_f32 v48, v136
    buffer_load_dwordx4 v[84:87], v57, s[12:15], 0 offen
    v_exp_f32 v49, v137
    s_bfe_u32 s38, s40, 0x40018
    v_pk_add_f32 v[48:49], v[48:49], 1.0 op_sel_hi:[1,0]
    v_rcp_f32 v48, v48
    v_rcp_f32 v49, v49
    s_set_gpr_idx_on s38, gpr_idx(SRC2,DST)
    v_pk_fma_f32 v[184:185], v[8:9], v[134:135], v[184:185] op_sel:[0,0,0] op_sel_hi:[1,0,1]
    v_pk_fma_f32 v[194:195], v[10:11], v[134:135], v[194:195] op_sel:[0,0,0] op_sel_hi:[1,0,1]
    v_pk_fma_f32 v[204:205], v[12:13], v[150:151], v[204:205] op_sel:[0,0,0] op_sel_hi:[1,0,1]
    v_pk_fma_f32 v[214:215], v[14:15], v[150:151], v[214:215] op_sel:[0,0,0] op_sel_hi:[1,0,1]
    s_set_gpr_idx_off
    v_pk_mul_f32 v[136:137], v[136:137], v[48:49]
    s_cmp_le_u32 s39, 8
    s_cbranch_scc1 K2_X_8
    s_cbranch_vccz K2_PLB
    s_setprio 0
K2_PLB:
    s_waitcnt vmcnt(5)
    v_mfma_f32_4x4x4_16b_bf16 v[8:11], v[42:43], v[64:65], 0 cbsz:3 abid:0
    v_mfma_f32_4x4x4_16b_bf16 v[12:15], v[42:43], v[66:67], 0 cbsz:3 abid:0
    v_add_u32_dpp v56, v52, v224 row_newbcast:14 row_mask:0xf bank_mask:0xf
    v_exp_f32 v48, v152
    buffer_load_dwordx4 v[88:91], v56, s[12:15], 0 offen
    v_exp_f32 v49, v153
    s_bfe_u32 s38, s40, 0x4001c
    v_pk_add_f32 v[48:49], v[48:49], 1.0 op_sel_hi:[1,0]
    v_rcp_f32 v48, v48
    v_rcp_f32 v49, v49
    s_set_gpr_idx_on s38, gpr_idx(SRC2,DST)
    v_pk_fma_f32 v[184:185], v[16:17], v[134:135], v[184:185] op_sel:[0,1,0] op_sel_hi:[1,1,1]
    v_pk_fma_f32 v[194:195], v[18:19], v[134:135], v[194:195] op_sel:[0,1,0] op_sel_hi:[1,1,1]
    v_pk_fma_f32 v[204:205], v[20:21], v[150:151], v[204:205] op_sel:[0,1,0] op_sel_hi:[1,1,1]
    v_pk_fma_f32 v[214:215], v[22:23], v[150:151], v[214:215] op_sel:[0,1,0] op_sel_hi:[1,1,1]
    s_set_gpr_idx_off
    v_pk_mul_f32 v[152:153], v[152:153], v[48:49]
    s_waitcnt vmcnt(5)
    v_mfma_f32_4x4x4_16b_bf16 v[16:19], v[42:43], v[68:69], 0 cbsz:3 abid:1
    v_mfma_f32_4x4x4_16b_bf16 v[20:23], v[42:43], v[70:71], 0 cbsz:3 abid:1
    v_add_u32_dpp v57, v52, v224 row_newbcast:15 row_mask:0xf bank_mask:0xf
    v_exp_f32 v48, v138
    buffer_load_dwordx4 v[92:95], v57, s[12:15], 0 offen
    v_exp_f32 v49, v139
    s_bfe_u32 s38, s41, 0x40000
    v_pk_add_f32 v[48:49], v[48:49], 1.0 op_sel_hi:[1,0]
    v_rcp_f32 v48, v48
    v_rcp_f32 v49, v49
    s_set_gpr_idx_on s38, gpr_idx(SRC2,DST)
    v_pk_fma_f32 v[184:185], v[8:9], v[136:137], v[184:185] op_sel:[0,0,0] op_sel_hi:[1,0,1]
    v_pk_fma_f32 v[194:195], v[10:11], v[136:137], v[194:195] op_sel:[0,0,0] op_sel_hi:[1,0,1]
    v_pk_fma_f32 v[204:205], v[12:13], v[152:153], v[204:205] op_sel:[0,0,0] op_sel_hi:[1,0,1]
    v_pk_fma_f32 v[214:215], v[14:15], v[152:153], v[214:215] op_sel:[0,0,0] op_sel_hi:[1,0,1]
    s_set_gpr_idx_off
    v_pk_mul_f32 v[138:139], v[138:139], v[48:49]
    s_cmp_le_u32 s39, 10
    s_cbranch_scc1 K2_X_10
    s_waitcnt vmcnt(5)
    v_mfma_f32_4x4x4_16b_bf16 v[8:11], v[42:43], v[72:73], 0 cbsz:3 abid:2
    v_mfma_f32_4x4x4_16b_bf16 v[12:15], v[42:43], v[74:75], 0 cbsz:3 abid:2
    v_exp_f32 v48, v154
    v_exp_f32 v49, v155
    s_bfe_u32 s38, s41, 0x40004
    v_pk_add_f32 v[48:49], v[48:49], 1.0 op_sel_hi:[1,0]
    v_rcp_f32 v48, v48
    v_rcp_f32 v49, v49
    s_set_gpr_idx_on s38, gpr_idx(SRC2,DST)
    v_pk_fma_f32 v[184:185], v[16:17], v[136:137], v[184:185] op_sel:[0,1,0] op_sel_hi:[1,1,1]
    v_pk_fma_f32 v[194:195], v[18:19], v[136:137], v[194:195] op_sel:[0,1,0] op_sel_hi:[1,1,1]
    v_pk_fma_f32 v[204:205], v[20:21], v[152:153], v[204:205] op_sel:[0,1,0] op_sel_hi:[1,1,1]
    v_pk_fma_f32 v[214:215], v[22:23], v[152:153], v[214:215] op_sel:[0,1,0] op_sel_hi:[1,1,1]
    s_set_gpr_idx_off
    v_pk_mul_f32 v[154:155], v[154:155], v[48:49]
    s_waitcnt vmcnt(4)
    v_mfma_f32_4x4x4_16b_bf16 v[16:19], v[42:43], v[76:77], 0 cbsz:3 abid:3
    v_mfma_f32_4x4x4_16b_bf16 v[20:23], v[42:43], v[78:79], 0 cbsz:3 abid:3
    v_exp_f32 v48, v140
    v_exp_f32 v49, v141
    s_bfe_u32 s38, s41, 0x40008
    v_pk_add_f32 v[48:49], v[48:49], 1.0 op_sel_hi:[1,0]
    v_rcp_f32 v48, v48
    v_rcp_f32 v49, v49
    s_set_gpr_idx_on s38, gpr_idx(SRC2,DST)
    v_pk_fma_f32 v[184:185], v[8:9], v[138:139], v[184:185] op_sel:[0,0,0] op_sel_hi:[1,0,1]
    v_pk_fma_f32 v[194:195], v[10:11], v[138:139], v[194:195] op_sel:[0,0,0] op_sel_hi:[1,0,1]
    v_pk_fma_f32 v[204:205], v[12:13], v[154:155], v[204:205] op_sel:[0,0,0] op_sel_hi:[1,0,1]
    v_pk_fma_f32 v[214:215], v[14:15], v[154:155], v[214:215] op_sel:[0,0,0] op_sel_hi:[1,0,1]
    s_set_gpr_idx_off
    v_pk_mul_f32 v[140:141], v[140:141], v[48:49]
    s_cmp_le_u32 s39, 12
    s_cbranch_scc1 K2_X_12
    s_waitcnt vmcnt(3)
    v_mfma_f32_4x4x4_16b_bf16 v[8:11], v[42:43], v[80:81], 0 cbsz:3 abid:4
    v_mfma_f32_4x4x4_16b_bf16 v[12:15], v[42:43], v[82:83], 0 cbsz:3 abid:4
    v_exp_f32 v48, v156
    v_exp_f32 v49, v157
    s_bfe_u32 s38, s41, 0x4000c
    v_pk_add_f32 v[48:49], v[48:49], 1.0 op_sel_hi:[1,0]
    v_rcp_f32 v48, v48
    v_rcp_f32 v49, v49
    s_set_gpr_idx_on s38, gpr_idx(SRC2,DST)
    v_pk_fma_f32 v[184:185], v[16:17], v[138:139], v[184:185] op_sel:[0,1,0] op_sel_hi:[1,1,1]
    v_pk_fma_f32 v[194:195], v[18:19], v[138:139], v[194:195] op_sel:[0,1,0] op_sel_hi:[1,1,1]
    v_pk_fma_f32 v[204:205], v[20:21], v[154:155], v[204:205] op_sel:[0,1,0] op_sel_hi:[1,1,1]
    v_pk_fma_f32 v[214:215], v[22:23], v[154:155], v[214:215] op_sel:[0,1,0] op_sel_hi:[1,1,1]
    s_set_gpr_idx_off
    v_pk_mul_f32 v[156:157], v[156:157], v[48:49]
    s_nop 0
    s_waitcnt vmcnt(2)
    v_mfma_f32_4x4x4_16b_bf16 v[16:19], v[42:43], v[84:85], 0 cbsz:3 abid:5
    v_mfma_f32_4x4x4_16b_bf16 v[20:23], v[42:43], v[86:87], 0 cbsz:3 abid:5
    v_exp_f32 v48, v142
    v_exp_f32 v49, v143
    s_bfe_u32 s38, s41, 0x40010
    v_pk_add_f32 v[48:49], v[48:49], 1.0 op_sel_hi:[1,0]
    v_rcp_f32 v48, v48
    v_rcp_f32 v49, v49
    s_set_gpr_idx_on s38, gpr_idx(SRC2,DST)
    v_pk_fma_f32 v[184:185], v[8:9], v[140:141], v[184:185] op_sel:[0,0,0] op_sel_hi:[1,0,1]
    v_pk_fma_f32 v[194:195], v[10:11], v[140:141], v[194:195] op_sel:[0,0,0] op_sel_hi:[1,0,1]
    v_pk_fma_f32 v[204:205], v[12:13], v[156:157], v[204:205] op_sel:[0,0,0] op_sel_hi:[1,0,1]
    v_pk_fma_f32 v[214:215], v[14:15], v[156:157], v[214:215] op_sel:[0,0,0] op_sel_hi:[1,0,1]
    s_set_gpr_idx_off
    v_pk_mul_f32 v[142:143], v[142:143], v[48:49]
    s_cmp_le_u32 s39, 14
    s_cbranch_scc1 K2_X_14
    s_waitcnt vmcnt(1)
    v_mfma_f32_4x4x4_16b_bf16 v[8:11], v[42:43], v[88:89], 0 cbsz:3 abid:6
    v_mfma_f32_4x4x4_16b_bf16 v[12:15], v[42:43], v[90:91], 0 cbsz:3 abid:6
    v_exp_f32 v48, v158
    v_exp_f32 v49, v159
    s_bfe_u32 s38, s41, 0x40014
    v_pk_add_f32 v[48:49], v[48:49], 1.0 op_sel_hi:[1,0]
    v_rcp_f32 v48, v48
    v_rcp_f32 v49, v49
    s_set_gpr_idx_on s38, gpr_idx(SRC2,DST)
    v_pk_fma_f32 v[184:185], v[16:17], v[140:141], v[184:185] op_sel:[0,1,0] op_sel_hi:[1,1,1]
    v_pk_fma_f32 v[194:195], v[18:19], v[140:141], v[194:195] op_sel:[0,1,0] op_sel_hi:[1,1,1]
    v_pk_fma_f32 v[204:205], v[20:21], v[156:157], v[204:205] op_sel:[0,1,0] op_sel_hi:[1,1,1]
    v_pk_fma_f32 v[214:215], v[22:23], v[156:157], v[214:215] op_sel:[0,1,0] op_sel_hi:[1,1,1]
    s_set_gpr_idx_off
    v_pk_mul_f32 v[158:159], v[158:159], v[48:49]
    s_waitcnt vmcnt(0)
    v_mfma_f32_4x4x4_16b_bf16 v[16:19], v[42:43], v[92:93], 0 cbsz:3 abid:7
    v_mfma_f32_4x4x4_16b_bf16 v[20:23], v[42:43], v[94:95], 0 cbsz:3 abid:7
    s_bfe_u32 s38, s41, 0x40018
    s_set_gpr_idx_on s38, gpr_idx(SRC2,DST)
    v_pk_fma_f32 v[184:185], v[8:9], v[142:143], v[184:185] op_sel:[0,0,0] op_sel_hi:[1,0,1]
    v_pk_fma_f32 v[194:195], v[10:11], v[142:143], v[194:195] op_sel:[0,0,0] op_sel_hi:[1,0,1]
    v_pk_fma_f32 v[204:205], v[12:13], v[158:159], v[204:205] op_sel:[0,0,0] op_sel_hi:[1,0,1]
    v_pk_fma_f32 v[214:215], v[14:15], v[158:159], v[214:215] op_sel:[0,0,0] op_sel_hi:[1,0,1]
    s_set_gpr_idx_off
    s_bfe_u32 s38, s41, 0x4001c
    s_set_gpr_idx_on s38, gpr_idx(SRC2,DST)
    v_pk_fma_f32 v[184:185], v[16:17], v[142:143], v[184:185] op_sel:[0,1,0] op_sel_hi:[1,1,1]
    v_pk_fma_f32 v[194:195], v[18:19], v[142:143], v[194:195] op_sel:[0,1,0] op_sel_hi:[1,1,1]
    v_pk_fma_f32 v[204:205], v[20:21], v[158:159], v[204:205] op_sel:[0,1,0] op_sel_hi:[1,1,1]
    v_pk_fma_f32 v[214:215], v[22:23], v[158:159], v[214:215] op_sel:[0,1,0] op_sel_hi:[1,1,1]
    s_set_gpr_idx_off
K2_DONE:
    s_cmp_lg_u32 s34, 0
    s_cbranch_scc1 K2_MORE
    s_mov_b32 s74, 0xbf317218
    s_mov_b32 s75, s74
    v_permlane32_swap_b32 v184, v194
    v_permlane32_swap_b32 v185, v195
    v_permlane32_swap_b32 v204, v214
    v_permlane32_swap_b32 v205, v215
    v_permlane32_swap_b32 v186, v196
    v_permlane32_swap_b32 v187, v197
    v_permlane32_swap_b32 v206, v216
    v_permlane32_swap_b32 v207, v217
    v_pk_add_f32 v[184:185], v[184:185], v[194:195]
    v_pk_add_f32 v[204:205], v[204:205], v[214:215]
    v_pk_mul_f32 v[184:185], v[184:185], s[74:75]
    v_pk_mul_f32 v[204:205], v[204:205], s[74:75]
    v_cvt_pk_bf16_f32 v40, v184, v204
    v_cvt_pk_bf16_f32 v41, v185, v205
    ds_write_b32 v241, v40 offset:0
    ds_write_b32 v241, v41 offset:144
    v_permlane32_swap_b32 v188, v198
    v_permlane32_swap_b32 v189, v199
    v_permlane32_swap_b32 v208, v218
    v_permlane32_swap_b32 v209, v219
    v_pk_add_f32 v[186:187], v[186:187], v[196:197]
    v_pk_add_f32 v[206:207], v[206:207], v[216:217]
    v_pk_mul_f32 v[186:187], v[186:187], s[74:75]
    v_pk_mul_f32 v[206:207], v[206:207], s[74:75]
    v_cvt_pk_bf16_f32 v42, v186, v206
    v_cvt_pk_bf16_f32 v43, v187, v207
    ds_write_b32 v241, v42 offset:576
    ds_write_b32 v241, v43 offset:720
    v_permlane32_swap_b32 v190, v200
    v_permlane32_swap_b32 v191, v201
    v_permlane32_swap_b32 v210, v220
    v_permlane32_swap_b32 v211, v221
    v_pk_add_f32 v[188:189], v[188:189], v[198:199]
    v_pk_add_f32 v[208:209], v[208:209], v[218:219]
    v_pk_mul_f32 v[188:189], v[188:189], s[74:75]
    v_pk_mul_f32 v[208:209], v[208:209], s[74:75]
    v_cvt_pk_bf16_f32 v44, v188, v208
    v_cvt_pk_bf16_f32 v45, v189, v209
    ds_write_b32 v241, v44 offset:1152
    ds_write_b32 v241, v45 offset:1296
    v_permlane32_swap_b32 v192, v202
    v_permlane32_swap_b32 v193, v203
    v_permlane32_swap_b32 v212, v222
    v_permlane32_swap_b32 v213, v223
    v_pk_add_f32 v[190:191], v[190:191], v[200:201]
    v_pk_add_f32 v[210:211], v[210:211], v[220:221]
    v_pk_mul_f32 v[190:191], v[190:191], s[74:75]
    v_pk_mul_f32 v[210:211], v[210:211], s[74:75]
    v_cvt_pk_bf16_f32 v46, v190, v210
    v_cvt_pk_bf16_f32 v47, v191, v211
    ds_write_b32 v241, v46 offset:1728
    ds_write_b32 v241, v47 offset:1872
    v_pk_add_f32 v[192:193], v[192:193], v[202:203]
    v_pk_add_f32 v[212:213], v[212:213], v[222:223]
    v_pk_mul_f32 v[192:193], v[192:193], s[74:75]
    v_pk_mul_f32 v[212:213], v[212:213], s[74:75]
    v_cvt_pk_bf16_f32 v48, v192, v212
    v_cvt_pk_bf16_f32 v49, v193, v213
    ds_write_b32 v241, v48 offset:2304
    ds_write_b32 v241, v49 offset:2448
    s_waitcnt lgkmcnt(0)
    ds_read_b128 v[8:11], v242 offset:0
    ds_read_b128 v[12:15], v242 offset:32
    ds_read_b128 v[16:19], v242 offset:64
    ds_read_b128 v[20:23], v242 offset:96
    s_waitcnt lgkmcnt(3)
    v_mfma_f32_32x32x16_bf16 v[128:143], v[8:11], v[96:99], 0
    v_mfma_f32_32x32x16_bf16 v[144:159], v[8:11], v[100:103], 0
    s_waitcnt lgkmcnt(2)
    v_mfma_f32_32x32x16_bf16 v[128:143], v[12:15], v[104:107], v[128:143]
    v_mfma_f32_32x32x16_bf16 v[144:159], v[12:15], v[108:111], v[144:159]
    s_waitcnt lgkmcnt(1)
    v_mfma_f32_32x32x16_bf16 v[128:143], v[16:19], v[112:115], v[128:143]
    v_mfma_f32_32x32x16_bf16 v[144:159], v[16:19], v[116:119], v[144:159]
    s_waitcnt lgkmcnt(0)
    v_mfma_f32_32x32x16_bf16 v[128:143], v[20:23], v[120:123], v[128:143]
    v_mfma_f32_32x32x16_bf16 v[144:159], v[20:23], v[124:127], v[144:159]
    s_movk_i32 s74, 0x2000
    s_movk_i32 s75, 0x4000
    s_nop 7
    s_nop 2
    v_cvt_pk_bf16_f32 v40, v128, v129
    v_cvt_pk_bf16_f32 v41, v130, v131
    v_cvt_pk_bf16_f32 v42, v144, v145
    v_cvt_pk_bf16_f32 v43, v146, v147
    s_mov_b64 exec, s[56:57]
    buffer_store_dwordx4 v[40:43], v244, s[20:23], 0 offen sc0 sc1
    s_mov_b64 exec, -1
    v_cvt_pk_bf16_f32 v44, v132, v133
    v_cvt_pk_bf16_f32 v45, v134, v135
    v_cvt_pk_bf16_f32 v46, v148, v149
    v_cvt_pk_bf16_f32 v47, v150, v151
    s_mov_b64 exec, s[58:59]
    buffer_store_dwordx4 v[44:47], v244, s[20:23], s74 offen sc0 sc1
    s_mov_b64 exec, -1
    v_cvt_pk_bf16_f32 v48, v136, v137
    v_cvt_pk_bf16_f32 v49, v138, v139
    v_cvt_pk_bf16_f32 v50, v152, v153
    v_cvt_pk_bf16_f32 v51, v154, v155
    s_mov_b64 exec, s[60:61]
    buffer_store_dwordx4 v[48:51], v244, s[20:23], s75 offen sc0 sc1
    s_mov_b64 exec, -1
K2_END:
    s_endpgm
K2_Wg:
    s_branch K1_BACK
K2_X_2:
    s_bfe_u32 s38, s40, 0x40004
    s_set_gpr_idx_on s38, gpr_idx(SRC2,DST)
    v_pk_fma_f32 v[184:185], v[16:17], v[128:129], v[184:185] op_sel:[0,1,0] op_sel_hi:[1,1,1]
    v_pk_fma_f32 v[194:195], v[18:19], v[128:129], v[194:195] op_sel:[0,1,0] op_sel_hi:[1,1,1]
    v_pk_fma_f32 v[204:205], v[20:21], v[144:145], v[204:205] op_sel:[0,1,0] op_sel_hi:[1,1,1]
    v_pk_fma_f32 v[214:215], v[22:23], v[144:145], v[214:215] op_sel:[0,1,0] op_sel_hi:[1,1,1]
    s_set_gpr_idx_off
    s_branch K2_DONE
K2_X_4:
    s_bfe_u32 s38, s40, 0x4000c
    s_set_gpr_idx_on s38, gpr_idx(SRC2,DST)
    v_pk_fma_f32 v[184:185], v[16:17], v[130:131], v[184:185] op_sel:[0,1,0] op_sel_hi:[1,1,1]
    v_pk_fma_f32 v[194:195], v[18:19], v[130:131], v[194:195] op_sel:[0,1,0] op_sel_hi:[1,1,1]
    v_pk_fma_f32 v[204:205], v[20:21], v[146:147], v[204:205] op_sel:[0,1,0] op_sel_hi:[1,1,1]
    v_pk_fma_f32 v[214:215], v[22:23], v[146:147], v[214:215] op_sel:[0,1,0] op_sel_hi:[1,1,1]
    s_set_gpr_idx_off
    s_branch K2_DONE
K2_X_6:
    s_bfe_u32 s38, s40, 0x40014
    s_set_gpr_idx_on s38, gpr_idx(SRC2,DST)
    v_pk_fma_f32 v[184:185], v[16:17], v[132:133], v[184:185] op_sel:[0,1,0] op_sel_hi:[1,1,1]
    v_pk_fma_f32 v[194:195], v[18:19], v[132:133], v[194:195] op_sel:[0,1,0] op_sel_hi:[1,1,1]
    v_pk_fma_f32 v[204:205], v[20:21], v[148:149], v[204:205] op_sel:[0,1,0] op_sel_hi:[1,1,1]
    v_pk_fma_f32 v[214:215], v[22:23], v[148:149], v[214:215] op_sel:[0,1,0] op_sel_hi:[1,1,1]
    s_set_gpr_idx_off
    s_branch K2_DONE
K2_X_8:
    s_bfe_u32 s38, s40, 0x4001c
    s_set_gpr_idx_on s38, gpr_idx(SRC2,DST)
    v_pk_fma_f32 v[184:185], v[16:17], v[134:135], v[184:185] op_sel:[0,1,0] op_sel_hi:[1,1,1]
    v_pk_fma_f32 v[194:195], v[18:19], v[134:135], v[194:195] op_sel:[0,1,0] op_sel_hi:[1,1,1]
    v_pk_fma_f32 v[204:205], v[20:21], v[150:151], v[204:205] op_sel:[0,1,0] op_sel_hi:[1,1,1]
    v_pk_fma_f32 v[214:215], v[22:23], v[150:151], v[214:215] op_sel:[0,1,0] op_sel_hi:[1,1,1]
    s_set_gpr_idx_off
    s_branch K2_DONE
K2_X_10:
    s_bfe_u32 s38, s41, 0x40004
    s_set_gpr_idx_on s38, gpr_idx(SRC2,DST)
    v_pk_fma_f32 v[184:185], v[16:17], v[136:137], v[184:185] op_sel:[0,1,0] op_sel_hi:[1,1,1]
    v_pk_fma_f32 v[194:195], v[18:19], v[136:137], v[194:195] op_sel:[0,1,0] op_sel_hi:[1,1,1]
    v_pk_fma_f32 v[204:205], v[20:21], v[152:153], v[204:205] op_sel:[0,1,0] op_sel_hi:[1,1,1]
    v_pk_fma_f32 v[214:215], v[22:23], v[152:153], v[214:215] op_sel:[0,1,0] op_sel_hi:[1,1,1]
    s_set_gpr_idx_off
    s_branch K2_DONE
K2_X_12:
    s_bfe_u32 s38, s41, 0x4000c
    s_set_gpr_idx_on s38, gpr_idx(SRC2,DST)
    v_pk_fma_f32 v[184:185], v[16:17], v[138:139], v[184:185] op_sel:[0,1,0] op_sel_hi:[1,1,1]
    v_pk_fma_f32 v[194:195], v[18:19], v[138:139], v[194:195] op_sel:[0,1,0] op_sel_hi:[1,1,1]
    v_pk_fma_f32 v[204:205], v[20:21], v[154:155], v[204:205] op_sel:[0,1,0] op_sel_hi:[1,1,1]
    v_pk_fma_f32 v[214:215], v[22:23], v[154:155], v[214:215] op_sel:[0,1,0] op_sel_hi:[1,1,1]
    s_set_gpr_idx_off
    s_branch K2_DONE
K2_X_14:
    s_bfe_u32 s38, s41, 0x40014
    s_set_gpr_idx_on s38, gpr_idx(SRC2,DST)
    v_pk_fma_f32 v[184:185], v[16:17], v[140:141], v[184:185] op_sel:[0,1,0] op_sel_hi:[1,1,1]
    v_pk_fma_f32 v[194:195], v[18:19], v[140:141], v[194:195] op_sel:[0,1,0] op_sel_hi:[1,1,1]
    v_pk_fma_f32 v[204:205], v[20:21], v[156:157], v[204:205] op_sel:[0,1,0] op_sel_hi:[1,1,1]
    v_pk_fma_f32 v[214:215], v[22:23], v[156:157], v[214:215] op_sel:[0,1,0] op_sel_hi:[1,1,1]
    s_set_gpr_idx_off
    s_branch K2_DONE
K2_EMPTY:
    v_lshlrev_b32 v240, 4, v1
    s_mul_i32 s76, s28, 2880
    s_add_u32 s76, s76, 12544
    v_lshrrev_b32 v241, 2, v224
    v_mad_u32_u24 v241, v225, 18, v241
    v_add_u32 v241, s76, v241
    v_mad_u32_u24 v242, v224, 9, v225
    v_add_u32 v242, s76, v242
    ds_read_b128 v[96:99], v240 offset:4352
    ds_read_b128 v[100:103], v240 offset:5376
    ds_read_b128 v[104:107], v240 offset:6400
    ds_read_b128 v[108:111], v240 offset:7424
    ds_read_b128 v[112:115], v240 offset:8448
    ds_read_b128 v[116:119], v240 offset:9472
    ds_read_b128 v[120:123], v240 offset:10496
    ds_read_b128 v[124:127], v240 offset:11520
    v_lshrrev_b32 v243, 1, v225
    v_add_u32 v243, s28, v243
    v_add_u32 v244, s30, v243
    v_lshl_add_u32 v244, v244, 9, v224
    v_add_u32 v245, 0, v243
    v_cmp_gt_u32 s[56:57], s31, v245
    v_add_u32 v245, 16, v243
    v_cmp_gt_u32 s[58:59], s31, v245
    v_add_u32 v245, 32, v243
    v_cmp_gt_u32 s[60:61], s31, v245
    s_branch K2_DONE
K2_MORE:
    s_waitcnt vmcnt(0) lgkmcnt(0)
    s_barrier
    v_lshrrev_b32 v32, 4, v1
    v_lshrrev_b32 v33, 1, v1
    s_lshl_b32 s74, s28, 15
    s_lshl_b32 s75, s29, 2
    v_lshlrev_b32 v32, 13, v32
    v_lshlrev_b32 v33, 10, v33
    s_add_u32 s74, s74, s75
    s_add_u32 s74, s74, 0x780000
    s_add_u32 s75, s74, 4096
    buffer_load_dword v8, v32, s[24:27], s74 offen offset:0
    buffer_load_dword v9, v32, s[24:27], s74 offen offset:1024
    buffer_load_dword v10, v32, s[24:27], s74 offen offset:2048
    buffer_load_dword v11, v32, s[24:27], s74 offen offset:3072
    buffer_load_dword v12, v32, s[24:27], s75 offen offset:0
    buffer_load_dword v13, v32, s[24:27], s75 offen offset:1024
    buffer_load_dword v14, v32, s[24:27], s75 offen offset:2048
    buffer_load_dword v15, v32, s[24:27], s75 offen offset:3072
    buffer_load_dword v16, v33, s[24:27], s74 offen
    s_add_u32 s32, s32, s33
    s_movk_i32 s33, 384
    s_waitcnt vmcnt(0) lgkmcnt(0)
    s_branch K2_ROUND
K2_NARROW:
    s_barrier
    s_movk_i32 s33, 192
    s_waitcnt vmcnt(0) lgkmcnt(0)
    s_branch K2_ROUND
.section .rodata,"a"
.p2align 6
.amdhsa_kernel tfn_sort_kernel
  .amdhsa_next_free_vgpr 56
  .amdhsa_next_free_sgpr 102
  .amdhsa_accum_offset 56
  .amdhsa_group_segment_fixed_size 0
  .amdhsa_kernarg_size 88
  .amdhsa_user_sgpr_count 2
  .amdhsa_user_sgpr_kernarg_segment_ptr 1
  .amdhsa_system_sgpr_workgroup_id_x 1
  .amdhsa_float_denorm_mode_32 3
.end_amdhsa_kernel
.p2align 6
.amdhsa_kernel gather_scatter__tensor_product_equiv_tfn__graph_kernel
  .amdhsa_next_free_vgpr 256
  .amdhsa_next_free_sgpr 102
  .amdhsa_accum_offset 256
  .amdhsa_group_segment_fixed_size 0
  .amdhsa_kernarg_size 88
  .amdhsa_user_sgpr_count 2
  .amdhsa_user_sgpr_kernarg_segment_ptr 1
  .amdhsa_system_sgpr_workgroup_id_x 1
  .amdhsa_float_denorm_mode_32 3
.end_amdhsa_kernel
```
